```python
import torch

def _softmax(x, axis=-1):
    return torch.softmax(x, dim=axis)
def _gelu(x):
    return torch.nn.functional.gelu(x, approximate="tanh")
def _silu(x):
    return torch.nn.functional.silu(x)
def _sigmoid(x):
    return torch.sigmoid(x)
def _layernorm(x, axis=-1, eps=1e-5):
    m = x.mean(dim=axis, keepdim=True)
    v = x.var(dim=axis, keepdim=True, unbiased=False)
    return (x - m) / torch.sqrt(v + eps)
def _scatter_add(tgt, idx, src, axis=0):
    return tgt.clone().index_add_(axis, idx, src)
def _segment_sum(src, seg, n):
    out = torch.zeros((n,) + src.shape[1:], dtype=src.dtype)
    return out.index_add_(0, seg, src)
def _pad(x, pw):
    flat = tuple(v for pair in reversed(pw) for v in pair)
    return torch.nn.functional.pad(x, flat)

kernel_name = 'gated_mix__spectral_gfnet__dense_activation_silu__prompt'

def setup_inputs():

    _w = (lambda a: (lambda t: t.to(torch.bfloat16) if t.is_floating_point() else t)(torch.as_tensor(a)))
    def _A_setup():
        B, S, D = 1, 2048, 512
        Df = D // 2 + 1
        return {
            "x": _w((lambda *s: torch.randn(*s, dtype=torch.bfloat16) * 0.05)(B, S, D)),
            "w_r": _w((lambda *s: torch.randn(*s, dtype=torch.bfloat16) * 0.4)(S, Df) * 0.02),
            "w_i": _w((lambda *s: torch.randn(*s, dtype=torch.bfloat16) * 0.4)(S, Df) * 0.02),
        }
    _A_in = _A_setup()

    def _B_setup():
        B, S, D, F = 1, 2048, 512, 1792
        return {
            "x": _w((lambda *s: torch.randn(*s, dtype=torch.bfloat16) * 0.05)(B, S, D)),
            "w1": _w((lambda *s: torch.randn(*s, dtype=torch.bfloat16) * 3.2)(D, F) * (D ** -0.5)),
            "w2": _w((lambda *s: torch.randn(*s, dtype=torch.bfloat16) * 0.05)(F, D) * (F ** -0.5)),
        }
    _B_in = _B_setup()

    return {
        "A_x": _A_in["x"],
        "A_w_r": _A_in["w_r"],
        "A_w_i": _A_in["w_i"],
        "B_x": _B_in["x"],
        "B_w1": _B_in["w1"],
        "B_w2": _B_in["w2"],
        "gate_w": _w((lambda *s: torch.randn(*s, dtype=torch.bfloat16) * 0.05)(512) * 16.0),
    }

def reference(A_x, A_w_r, A_w_i, B_x, B_w1, B_w2, gate_w):
    def _A_ref(x, w_r, w_i):
        B, S, D = x.shape
        X = (lambda x, axes=(-2,-1): torch.fft.rfft2(x.float(), dim=axes))(x, axes=(-2, -1))
        W = w_r + 1j * w_i
        X = X * W
        y = (lambda x, s, axes=(-2,-1): torch.fft.irfft2(x, s=s, dim=axes).to(torch.bfloat16))(X, (S, D), axes=(-2, -1))
        return y

    def _B_ref(x, w1, w2):
        h = torch.einsum("bsd,df->bsf", x, w1)
        h = _silu(h)
        out = torch.einsum("bsf,fd->bsd", h, w2)
        return out

    x = A_x
    g = _sigmoid((x * gate_w).sum(-1, keepdims=True))
    a = _A_ref(x, A_w_r, A_w_i)
    b = _B_ref(x, B_w1, B_w2)
    return g * a + (1 - g) * b
```

```asm
; @launch grid=(256,1,1) block=(512,1,1) lds=163840
.amdgcn_target "amdgcn-amd-amdhsa--gfx950"
.text
.globl gated_mix__spectral_gfnet__dense_activation_silu__prompt_kernel
.p2align 8
.type gated_mix__spectral_gfnet__dense_activation_silu__prompt_kernel,@function
gated_mix__spectral_gfnet__dense_activation_silu__prompt_kernel:
  s_cmp_ge_u32 s2, 256
  s_cbranch_scc1 L_end
  s_load_dwordx2 s[28:29], s[0:1], 0
  s_load_dwordx2 s[36:37], s[0:1], 72
  s_load_dwordx2 s[40:41], s[0:1], 48
  v_lshrrev_b32 v1, 6, v0
  v_and_b32 v0, 63, v0
  v_readfirstlane_b32 s60, v1
  s_and_b32 s61, s2, 7
  s_lshr_b32 s62, s2, 3
  s_and_b32 s66, s62, 7
  s_and_b32 s3, s2, 4
  s_lshr_b32 s4, s2, 5
  s_lshl1_add_u32 s63, s3, s4
  s_and_b32 s3, s2, 3
  s_and_b32 s4, s62, 3
  s_lshl2_add_u32 s64, s3, s4
  s_mul_i32 s4, s4, 5
  s_and_b32 s4, s4, 6
  s_xor_b32 s4, s4, s3
  s_xor_b32 s65, s63, s4
  s_and_b32 s65, s65, 7
  s_mov_b32 s30, 0x200000
  s_mov_b32 s31, 0x20000
  s_mov_b32 s38, 0x1600000
  s_mov_b32 s39, 0x20000
  s_mov_b32 s67, 0
  v_lshlrev_b32 v2, 4, v0
  s_cmp_ge_u32 s60, 4
  s_cbranch_scc1 L_F
  s_lshl2_add_u32 s5, s63, s60
  s_setprio 1
  v_lshrrev_b32 v240, 3, v0
  v_and_b32 v241, 48, v0
  v_xor_b32 v241, v241, v2
  v_and_b32 v241, 0x70, v241
  v_lshl_or_b32 v4, v240, 16, v241
  v_xor_b32 v5, 64, v4
  v_add_u32 v5, 523264, v5
  v_add_u32 v6, 1046528, v4
  v_add_u32 v7, 1046528, v5
  v_lshrrev_b32 v241, 5, v0
  s_lshl3_add_u32 s4, s5, s65
  s_lshl_b32 s4, s4, 7
  s_lshl_b32 s6, s60, 12
  s_add_u32 m0, s6, 49152
  s_lshl_b32 s3, s65, 7
  v_xor_b32 v254, s3, v2
  s_lshl_b32 s7, s60, 10
  s_add_u32 s7, s7, 147456
  s_mov_b32 s42, 0x400
  s_mov_b32 s43, 0x20000
  s_waitcnt lgkmcnt(0)
  buffer_load_dwordx4 v4, s[28:31], s4 offen offset:0 lds
  buffer_load_dwordx4 v5, s[28:31], s4 offen offset:1024 lds
  buffer_load_dwordx4 v6, s[28:31], s4 offen offset:2048 lds
  buffer_load_dwordx4 v7, s[28:31], s4 offen offset:3072 lds
  s_mov_b32 m0, s7
s_nop 0
  buffer_load_dwordx4 v254, s[40:43], 0 offen lds
  s_xor_b32 s3, s4, 512
  s_add_u32 m0, s6, 65536
s_nop 0
  buffer_load_dwordx4 v4, s[28:31], s3 offen offset:0 lds
  buffer_load_dwordx4 v5, s[28:31], s3 offen offset:1024 lds
  buffer_load_dwordx4 v6, s[28:31], s3 offen offset:2048 lds
  buffer_load_dwordx4 v7, s[28:31], s3 offen offset:3072 lds
  s_xor_b32 s3, s4, 128
  s_add_u32 m0, s6, 81920
s_nop 0
  buffer_load_dwordx4 v4, s[28:31], s3 offen offset:0 lds
  buffer_load_dwordx4 v5, s[28:31], s3 offen offset:1024 lds
  buffer_load_dwordx4 v6, s[28:31], s3 offen offset:2048 lds
  buffer_load_dwordx4 v7, s[28:31], s3 offen offset:3072 lds
  s_lshl_b32 s3, s64, 4
  v_and_or_b32 v147, v0, 15, s3
  v_and_b32 v144, 16, v0
  v_cvt_f32_u32 v145, v144
  v_mul_f32 v145, 0xbc800000, v145
  v_lshl_add_u32 v144, v147, 5, v144
  v_cmp_eq_u32 vcc, 16, v144
  v_cvt_f32_u32 v147, v147
  v_mul_f32 v147, 0xbb000000, v147
  v_cndmask_b32 v147, v147, 0.5, vcc
  v_cndmask_b32 v145, v145, 0, vcc
  s_xor_b32 s3, s60, s65
  s_lshl_b32 s3, s3, 6
  v_lshl_add_u32 v146, v241, 5, s3
  v_cvt_f32_u32 v146, v146
  v_fma_f32 v146, v146, v147, v145
  v_fract_f32 v146, v146
  s_lshl_b32 s3, s60, 12
  s_add_u32 s3, s3, 131072
  v_add_u32 v152, s3, v2
  s_mov_b32 s3, 0
L_ft:
  v_cos_f32 v144, v146
  v_add_f32 v146, v146, v147
  v_cos_f32 v145, v146
  v_add_f32 v146, v146, v147
  v_cvt_pk_bf16_f32 v148, v144, v145
  v_cos_f32 v144, v146
  v_add_f32 v146, v146, v147
  v_cos_f32 v145, v146
  v_add_f32 v146, v146, v147
  v_cvt_pk_bf16_f32 v149, v144, v145
  v_cos_f32 v144, v146
  v_add_f32 v146, v146, v147
  v_cos_f32 v145, v146
  v_add_f32 v146, v146, v147
  v_cvt_pk_bf16_f32 v150, v144, v145
  v_cos_f32 v144, v146
  v_add_f32 v146, v146, v147
  v_cos_f32 v145, v146
  v_add_f32 v146, v146, v147
  v_cvt_pk_bf16_f32 v151, v144, v145
  ds_write_b128 v152, v[148:151]
  s_add_u32 s3, s3, 1
  v_add_u32 v152, 1024, v152
  s_cmp_lt_u32 s3, 4
  s_cbranch_scc1 L_ft
  v_and_b32 v242, 31, v0
  v_cvt_f32_u32 v249, v242
  v_mul_f32 v249, 0xbd000000, v249
  v_lshl_add_u32 v248, v241, 8, s5
  v_cvt_f32_u32 v248, v248
  v_mul_f32 v248, 0x3c800000, v248
  v_mul_f32 v248, v248, v249
  v_or_b32 v10, s64, v241
  v_cmp_ne_u32 vcc, 0, v10
s_nop 1
  v_cndmask_b32 v10, 0, 1.0, vcc
  v_lshl_or_b32 v253, v0, 31, 1.0
  v_and_b32 v15, 28, v0
  v_lshl_add_u32 v15, v241, 1, v15
  v_lshlrev_b32 v15, 16, v15
  v_and_or_b32 v15, v2, 48, v15
  v_xor_b32 v254, v2, v0
  v_and_b32 v254, 16, v254
  v_lshl_add_u32 v254, v254, 6, v241
  v_lshl_add_u32 v254, v254, 6, s7
  v_lshlrev_b32 v250, 2, v242
  v_bfe_u32 v242, v0, 2, 2
  v_lshl_add_u32 v242, v241, 5, v242
  v_lshlrev_b32 v8, 7, v242
  v_and_b32 v242, 8, v0
  v_lshl_add_u32 v8, v242, 3, v8
  v_and_b32 v242, 16, v0
  v_lshl_add_u32 v8, v242, 1, v8
  v_and_b32 v14, 3, v0
  v_lshl_add_u32 v8, v14, 3, v8
  v_xor_b32 v9, 64, v8
  v_lshlrev_b32 v14, 2, v14
  v_add_u32 v1, 159744, v14
  s_lshl2_add_u32 s14, s60, 159744
  v_mov_b32 v13, s14
  v_add_u32 v11, 131072, v2
  v_cos_f32 v240, v248
  v_sin_f32 v244, v248
  v_add_f32 v248, v248, v249
  v_cos_f32 v241, v248
  v_sin_f32 v245, v248
  v_add_f32 v248, v248, v249
  v_cos_f32 v242, v248
  v_sin_f32 v246, v248
  v_add_f32 v248, v248, v249
  v_cos_f32 v243, v248
  v_sin_f32 v247, v248
  v_add_f32 v248, v248, v249
  v_cvt_pk_bf16_f32 v224, v240, v241
  v_cvt_pk_bf16_f32 v232, v244, v245
  v_cvt_pk_bf16_f32 v225, v242, v243
  v_cvt_pk_bf16_f32 v233, v246, v247
  v_fma_f32 v248, v249, 4.0, v248
  v_cos_f32 v240, v248
  v_sin_f32 v244, v248
  v_add_f32 v248, v248, v249
  v_cos_f32 v241, v248
  v_sin_f32 v245, v248
  v_add_f32 v248, v248, v249
  v_cos_f32 v242, v248
  v_sin_f32 v246, v248
  v_add_f32 v248, v248, v249
  v_cos_f32 v243, v248
  v_sin_f32 v247, v248
  v_add_f32 v248, v248, v249
  v_cvt_pk_bf16_f32 v226, v240, v241
  v_cvt_pk_bf16_f32 v234, v244, v245
  v_cvt_pk_bf16_f32 v227, v242, v243
  v_cvt_pk_bf16_f32 v235, v246, v247
  v_fma_f32 v248, v249, 4.0, v248
  v_cos_f32 v240, v248
  v_sin_f32 v244, v248
  v_add_f32 v248, v248, v249
  v_cos_f32 v241, v248
  v_sin_f32 v245, v248
  v_add_f32 v248, v248, v249
  v_cos_f32 v242, v248
  v_sin_f32 v246, v248
  v_add_f32 v248, v248, v249
  v_cos_f32 v243, v248
  v_sin_f32 v247, v248
  v_add_f32 v248, v248, v249
  v_cvt_pk_bf16_f32 v228, v240, v241
  v_cvt_pk_bf16_f32 v236, v244, v245
  v_cvt_pk_bf16_f32 v229, v242, v243
  v_cvt_pk_bf16_f32 v237, v246, v247
  v_fma_f32 v248, v249, 4.0, v248
  v_cos_f32 v240, v248
  v_sin_f32 v244, v248
  v_add_f32 v248, v248, v249
  v_cos_f32 v241, v248
  v_sin_f32 v245, v248
  v_add_f32 v248, v248, v249
  v_cos_f32 v242, v248
  v_sin_f32 v246, v248
  v_add_f32 v248, v248, v249
  v_cos_f32 v243, v248
  v_sin_f32 v247, v248
  v_add_f32 v248, v248, v249
  v_cvt_pk_bf16_f32 v230, v240, v241
  v_cvt_pk_bf16_f32 v238, v244, v245
  v_cvt_pk_bf16_f32 v231, v242, v243
  v_cvt_pk_bf16_f32 v239, v246, v247
  v_lshlrev_b32 v240, 3, v0
  v_lshlrev_b32 v241, 1, v0
  v_and_b32 v241, 64, v241
  v_xor_b32 v240, v240, v241
  v_and_b32 v240, 0x70, v240
  v_lshl_add_u32 v240, v250, 5, v240
  s_add_u32 s3, s6, 49152
  v_add_u32 v208, s3, v240
  v_xor_b32 v209, 16, v208
  v_xor_b32 v210, 32, v208
  v_xor_b32 v211, 48, v208
  s_waitcnt lgkmcnt(0)
  s_mov_b32 s15, 0xbfb8aa3b
  s_barrier
  s_buffer_load_dword s68, s[36:39], 0
  ds_read_b128 v[176:179], v11 offset:0
  ds_read_b128 v[180:183], v11 offset:1024
  ds_read_b128 v[184:187], v11 offset:2048
  ds_read_b128 v[188:191], v11 offset:3072
  ds_read_b128 v[192:195], v11 offset:4096
  ds_read_b128 v[196:199], v11 offset:5120
  ds_read_b128 v[200:203], v11 offset:6144
  ds_read_b128 v[204:207], v11 offset:7168
  s_xor_b32 s3, s4, 640
  s_add_u32 m0, s6, 98304
s_nop 0
  buffer_load_dwordx4 v4, s[28:31], s3 offen offset:0 lds
  buffer_load_dwordx4 v5, s[28:31], s3 offen offset:1024 lds
  buffer_load_dwordx4 v6, s[28:31], s3 offen offset:2048 lds
  buffer_load_dwordx4 v7, s[28:31], s3 offen offset:3072 lds
  s_mov_b32 m0, s14
  s_mov_b64 exec, 1
  buffer_load_dword off, s[28:31], s30 offset:832 lds
  s_mov_b64 exec, -1
  s_lshl4_add_u32 s3, s63, s64
  s_mul_i32 s24, s64, 17
  s_and_b32 s24, s24, 0xc3
  s_lshl2_add_u32 s24, s63, s24
  s_lshl2_add_u32 s24, s24, s60
  s_lshl_b32 s24, s24, 13
  s_xor_b32 s25, s24, 0
  s_add_u32 s16, s25, 0x420000
  s_xor_b32 s25, s24, 32768
  s_add_u32 s17, s25, 0x420000
  s_xor_b32 s25, s24, 65536
  s_add_u32 s18, s25, 0x420000
  s_xor_b32 s25, s24, 98304
  s_add_u32 s19, s25, 0x420000
  s_andn2_b32 s25, s24, 98304
  s_add_u32 s20, s25, 0x420000
  s_add_u32 s21, s25, 0x438000
  s_and_b32 s25, s3, -4
  s_add_u32 s26, s25, s60
  s_lshl_b32 s26, s26, 9
  s_add_u32 s7, s26, 0x1480000
  s_and_b32 s26, s3, 3
  s_lshl2_add_u32 s44, s26, s7
  s_lshl2_add_u32 s26, s5, s26
  s_lshr_b32 s27, s64, 2
  s_lshl_b32 s25, s26, 5
  s_add_u32 s25, s25, s27
  s_lshl2_add_u32 s23, s25, 0x14a0000
  s_lshl2_add_u32 s26, s26, s27
  s_mul_i32 s26, s26, 8192
  s_add_u32 s22, s26, 0xc20000
  s_cmp_eq_u32 s27, s60
  s_cselect_b32 s22, s38, s22
  s_cselect_b32 s45, 2, 4
  s_lshl_b32 s45, s45, 16
  s_lshl4_add_u32 s11, s64, s63
  s_and_b32 s12, s60, 1
  s_lshr_b32 s13, s60, 1
  s_lshl1_add_u32 s11, s11, s12
  s_lshl1_add_u32 s11, s11, s13
  s_lshl_b32 s11, s11, 6
  s_add_u32 s11, s11, 0x10000
  s_and_b32 s3, s64, 1
  s_lshl1_add_u32 s3, s63, s3
  s_lshl1_add_u32 s3, s3, s12
  s_andn2_b32 s12, s64, 1
  s_cselect_b32 s24, 16, 32
  s_lshl4_add_u32 s3, s3, s12
  s_add_u32 s3, s3, s13
  s_lshl_b32 s3, s3, 7
  s_add_u32 s3, s3, 0x1450000
  v_add_u32 v255, s3, v250
  s_lshl_b32 s13, s5, 7
  s_add_u32 s13, s13, 0x8000
  s_cmp_eq_u32 s64, 0
  s_cselect_b32 s13, s13, 0x80000000
  s_add_u32 s12, s11, 0x10000
  s_mov_b32 exec_hi, 0
  v_add_u32 v255, s13, v250
  s_mov_b32 exec_hi, -1
  s_waitcnt vmcnt(14)
  ds_read_b128 v[16:19], v208 offset:0
  ds_read_b128 v[20:23], v209 offset:0
  ds_read_b128 v[24:27], v210 offset:0
  ds_read_b128 v[28:31], v211 offset:0
  s_waitcnt lgkmcnt(0)
  s_xor_b32 s3, s4, 256
  s_add_u32 m0, s6, 49152
s_nop 0
  buffer_load_dwordx4 v4, s[28:31], s3 offen offset:0 lds
  buffer_load_dwordx4 v5, s[28:31], s3 offen offset:1024 lds
  buffer_load_dwordx4 v6, s[28:31], s3 offen offset:2048 lds
  buffer_load_dwordx4 v7, s[28:31], s3 offen offset:3072 lds
  s_waitcnt lgkmcnt(0)
  s_and_b32 s68, s68, -16
  s_add_u32 s68, s68, 17
  s_sub_u32 s24, s68, s24
  v_mov_b32 v12, s24
  s_waitcnt vmcnt(17)
  ds_read_b128 v[240:243], v254 offset:0
  ds_read_b128 v[244:247], v254 offset:16
  ds_read_b128 v[212:215], v254 offset:32
  ds_read_b128 v[216:219], v254 offset:48
  s_waitcnt vmcnt(13)
  ds_read_b128 v[80:83], v208 offset:16384
  ds_read_b128 v[84:87], v209 offset:16384
  ds_read_b128 v[88:91], v210 offset:16384
  ds_read_b128 v[92:95], v211 offset:16384
  v_mfma_f32_32x32x16_bf16 v[144:159], v[16:19], v[176:179], 0
  v_mfma_f32_32x32x16_bf16 v[144:159], v[20:23], v[180:183], v[144:159]
  v_mfma_f32_32x32x16_bf16 v[144:159], v[24:27], v[184:187], v[144:159]
  v_mfma_f32_32x32x16_bf16 v[144:159], v[28:31], v[188:191], v[144:159]
  s_waitcnt lgkmcnt(0)
  s_xor_b32 s3, s4, 768
  s_add_u32 m0, s6, 65536
s_nop 0
  buffer_load_dwordx4 v4, s[28:31], s3 offen offset:0 lds
  buffer_load_dwordx4 v5, s[28:31], s3 offen offset:1024 lds
  buffer_load_dwordx4 v6, s[28:31], s3 offen offset:2048 lds
  buffer_load_dwordx4 v7, s[28:31], s3 offen offset:3072 lds
  v_mfma_f32_16x16x32_bf16 v[220:223], v[240:243], v[16:19], 0
  v_mfma_f32_16x16x32_bf16 v[220:223], v[244:247], v[20:23], v[220:223]
  v_mfma_f32_16x16x32_bf16 v[220:223], v[212:215], v[24:27], v[220:223]
  v_mfma_f32_16x16x32_bf16 v[220:223], v[216:219], v[28:31], v[220:223]
  ds_read_b128 v[240:243], v254 offset:512
  ds_read_b128 v[244:247], v254 offset:528
  ds_read_b128 v[212:215], v254 offset:544
  ds_read_b128 v[216:219], v254 offset:560
  s_waitcnt vmcnt(13)
  ds_read_b128 v[32:35], v208 offset:32768
  ds_read_b128 v[36:39], v209 offset:32768
  ds_read_b128 v[40:43], v210 offset:32768
  ds_read_b128 v[44:47], v211 offset:32768
  v_mfma_f32_32x32x16_bf16 v[160:175], v[80:83], v[176:179], 0
  v_mfma_f32_32x32x16_bf16 v[160:175], v[84:87], v[180:183], v[160:175]
  v_mfma_f32_32x32x16_bf16 v[160:175], v[88:91], v[184:187], v[160:175]
  v_mfma_f32_32x32x16_bf16 v[160:175], v[92:95], v[188:191], v[160:175]
  s_waitcnt lgkmcnt(0)
  s_xor_b32 s3, s4, 384
  s_add_u32 m0, s6, 81920
s_nop 0
  buffer_load_dwordx4 v4, s[28:31], s3 offen offset:0 lds
  buffer_load_dwordx4 v5, s[28:31], s3 offen offset:1024 lds
  buffer_load_dwordx4 v6, s[28:31], s3 offen offset:2048 lds
  buffer_load_dwordx4 v7, s[28:31], s3 offen offset:3072 lds
  ds_read_b128 v[176:179], v11 offset:8192
  ds_read_b128 v[180:183], v11 offset:9216
  ds_read_b128 v[184:187], v11 offset:10240
  ds_read_b128 v[188:191], v11 offset:11264
  v_mfma_f32_16x16x32_bf16 v[220:223], v[240:243], v[80:83], v[220:223]
  v_mfma_f32_16x16x32_bf16 v[220:223], v[244:247], v[84:87], v[220:223]
  v_mfma_f32_16x16x32_bf16 v[220:223], v[212:215], v[88:91], v[220:223]
  v_mfma_f32_16x16x32_bf16 v[220:223], v[216:219], v[92:95], v[220:223]
  ds_read_b128 v[240:243], v254 offset:128
  ds_read_b128 v[244:247], v254 offset:144
  ds_read_b128 v[212:215], v254 offset:160
  ds_read_b128 v[216:219], v254 offset:176
  s_waitcnt vmcnt(13)
  ds_read_b128 v[96:99], v208 offset:49152
  ds_read_b128 v[100:103], v209 offset:49152
  ds_read_b128 v[104:107], v210 offset:49152
  ds_read_b128 v[108:111], v211 offset:49152
  v_mfma_f32_32x32x16_bf16 v[144:159], v[32:35], v[192:195], v[144:159]
  v_mfma_f32_32x32x16_bf16 v[144:159], v[36:39], v[196:199], v[144:159]
  v_mfma_f32_32x32x16_bf16 v[144:159], v[40:43], v[200:203], v[144:159]
  v_mfma_f32_32x32x16_bf16 v[144:159], v[44:47], v[204:207], v[144:159]
  s_waitcnt lgkmcnt(0)
  s_xor_b32 s3, s4, 896
  s_add_u32 m0, s6, 98304
s_nop 0
  buffer_load_dwordx4 v4, s[28:31], s3 offen offset:0 lds
  buffer_load_dwordx4 v5, s[28:31], s3 offen offset:1024 lds
  buffer_load_dwordx4 v6, s[28:31], s3 offen offset:2048 lds
  buffer_load_dwordx4 v7, s[28:31], s3 offen offset:3072 lds
  v_mfma_f32_16x16x32_bf16 v[220:223], v[240:243], v[32:35], v[220:223]
  v_mfma_f32_16x16x32_bf16 v[220:223], v[244:247], v[36:39], v[220:223]
  v_mfma_f32_16x16x32_bf16 v[220:223], v[212:215], v[40:43], v[220:223]
  v_mfma_f32_16x16x32_bf16 v[220:223], v[216:219], v[44:47], v[220:223]
  ds_read_b128 v[240:243], v254 offset:640
  ds_read_b128 v[244:247], v254 offset:656
  ds_read_b128 v[212:215], v254 offset:672
  ds_read_b128 v[216:219], v254 offset:688
  s_waitcnt vmcnt(12)
  ds_read_b128 v[48:51], v208 offset:0
  ds_read_b128 v[52:55], v209 offset:0
  ds_read_b128 v[56:59], v210 offset:0
  ds_read_b128 v[60:63], v211 offset:0
  v_mfma_f32_32x32x16_bf16 v[160:175], v[96:99], v[192:195], v[160:175]
  v_mfma_f32_32x32x16_bf16 v[160:175], v[100:103], v[196:199], v[160:175]
  v_mfma_f32_32x32x16_bf16 v[160:175], v[104:107], v[200:203], v[160:175]
  v_mfma_f32_32x32x16_bf16 v[160:175], v[108:111], v[204:207], v[160:175]
  s_waitcnt lgkmcnt(0)
  s_mov_b32 m0, s14
  s_mov_b64 exec, 1
  buffer_load_dword off, s[28:31], s30 offset:768 lds
  s_mov_b64 exec, -1
  ds_read_b128 v[192:195], v11 offset:12288
  ds_read_b128 v[196:199], v11 offset:13312
  ds_read_b128 v[200:203], v11 offset:14336
  ds_read_b128 v[204:207], v11 offset:15360
  v_mfma_f32_16x16x32_bf16 v[220:223], v[240:243], v[96:99], v[220:223]
  v_mfma_f32_16x16x32_bf16 v[220:223], v[244:247], v[100:103], v[220:223]
  v_mfma_f32_16x16x32_bf16 v[220:223], v[212:215], v[104:107], v[220:223]
  v_mfma_f32_16x16x32_bf16 v[220:223], v[216:219], v[108:111], v[220:223]
  ds_read_b128 v[240:243], v254 offset:256
  ds_read_b128 v[244:247], v254 offset:272
  ds_read_b128 v[212:215], v254 offset:288
  ds_read_b128 v[216:219], v254 offset:304
  s_waitcnt vmcnt(9)
  ds_read_b128 v[112:115], v208 offset:16384
  ds_read_b128 v[116:119], v209 offset:16384
  ds_read_b128 v[120:123], v210 offset:16384
  ds_read_b128 v[124:127], v211 offset:16384
  v_mfma_f32_32x32x16_bf16 v[144:159], v[48:51], v[176:179], v[144:159]
  v_mfma_f32_32x32x16_bf16 v[144:159], v[52:55], v[180:183], v[144:159]
  v_mfma_f32_32x32x16_bf16 v[144:159], v[56:59], v[184:187], v[144:159]
  v_mfma_f32_32x32x16_bf16 v[144:159], v[60:63], v[188:191], v[144:159]
  s_waitcnt lgkmcnt(0)
  s_mov_b32 m0, s14
  s_mov_b64 exec, 1
  buffer_load_dword off, s[28:31], s30 offset:784 lds
  s_mov_b64 exec, -1
  v_mfma_f32_16x16x32_bf16 v[220:223], v[240:243], v[48:51], v[220:223]
  v_mfma_f32_16x16x32_bf16 v[220:223], v[244:247], v[52:55], v[220:223]
  v_mfma_f32_16x16x32_bf16 v[220:223], v[212:215], v[56:59], v[220:223]
  v_mfma_f32_16x16x32_bf16 v[220:223], v[216:219], v[60:63], v[220:223]
  ds_read_b128 v[240:243], v254 offset:768
  ds_read_b128 v[244:247], v254 offset:784
  ds_read_b128 v[212:215], v254 offset:800
  ds_read_b128 v[216:219], v254 offset:816
  s_waitcnt vmcnt(6)
  ds_read_b128 v[64:67], v208 offset:32768
  ds_read_b128 v[68:71], v209 offset:32768
  ds_read_b128 v[72:75], v210 offset:32768
  ds_read_b128 v[76:79], v211 offset:32768
  v_mfma_f32_32x32x16_bf16 v[160:175], v[112:115], v[176:179], v[160:175]
  v_mfma_f32_32x32x16_bf16 v[160:175], v[116:119], v[180:183], v[160:175]
  v_mfma_f32_32x32x16_bf16 v[160:175], v[120:123], v[184:187], v[160:175]
  v_mfma_f32_32x32x16_bf16 v[160:175], v[124:127], v[188:191], v[160:175]
  s_waitcnt lgkmcnt(0)
  s_mov_b32 m0, s14
  s_mov_b64 exec, 1
  buffer_load_dword off, s[28:31], s30 offset:800 lds
  s_mov_b64 exec, -1
  v_mfma_f32_16x16x32_bf16 v[220:223], v[240:243], v[112:115], v[220:223]
  v_mfma_f32_16x16x32_bf16 v[220:223], v[244:247], v[116:119], v[220:223]
  v_mfma_f32_16x16x32_bf16 v[220:223], v[212:215], v[120:123], v[220:223]
  v_mfma_f32_16x16x32_bf16 v[220:223], v[216:219], v[124:127], v[220:223]
  ds_read_b128 v[240:243], v254 offset:384
  ds_read_b128 v[244:247], v254 offset:400
  ds_read_b128 v[212:215], v254 offset:416
  ds_read_b128 v[216:219], v254 offset:432
  s_waitcnt vmcnt(3)
  ds_read_b128 v[128:131], v208 offset:49152
  ds_read_b128 v[132:135], v209 offset:49152
  ds_read_b128 v[136:139], v210 offset:49152
  ds_read_b128 v[140:143], v211 offset:49152
  v_mfma_f32_32x32x16_bf16 v[144:159], v[64:67], v[192:195], v[144:159]
  v_mfma_f32_32x32x16_bf16 v[144:159], v[68:71], v[196:199], v[144:159]
  v_mfma_f32_32x32x16_bf16 v[144:159], v[72:75], v[200:203], v[144:159]
  v_mfma_f32_32x32x16_bf16 v[144:159], v[76:79], v[204:207], v[144:159]
  s_waitcnt lgkmcnt(0)
  s_mov_b32 m0, s14
  s_mov_b64 exec, 1
  buffer_load_dword off, s[28:31], s30 offset:816 lds
  s_mov_b64 exec, -1
  v_mfma_f32_32x32x16_bf16 v[160:175], v[128:131], v[192:195], v[160:175]
  v_mfma_f32_32x32x16_bf16 v[160:175], v[132:135], v[196:199], v[160:175]
  v_mfma_f32_32x32x16_bf16 v[160:175], v[136:139], v[200:203], v[160:175]
  v_mfma_f32_32x32x16_bf16 v[160:175], v[140:143], v[204:207], v[160:175]
  v_mfma_f32_16x16x32_bf16 v[220:223], v[240:243], v[64:67], v[220:223]
  v_mfma_f32_16x16x32_bf16 v[220:223], v[244:247], v[68:71], v[220:223]
  v_mfma_f32_16x16x32_bf16 v[220:223], v[212:215], v[72:75], v[220:223]
  v_mfma_f32_16x16x32_bf16 v[220:223], v[216:219], v[76:79], v[220:223]
  ds_read_b128 v[240:243], v254 offset:896
  ds_read_b128 v[244:247], v254 offset:912
  ds_read_b128 v[212:215], v254 offset:928
  ds_read_b128 v[216:219], v254 offset:944
  v_fmac_f32 v144, v253, v160
  v_fmac_f32 v145, v253, v161
  v_fmac_f32 v146, v253, v162
  v_fmac_f32 v147, v253, v163
  v_fmac_f32 v148, v253, v164
  v_fmac_f32 v149, v253, v165
  v_fmac_f32 v150, v253, v166
  v_fmac_f32 v151, v253, v167
  v_fmac_f32 v152, v253, v168
  v_fmac_f32 v153, v253, v169
  v_fmac_f32 v154, v253, v170
  v_fmac_f32 v155, v253, v171
  v_fmac_f32 v156, v253, v172
  v_fmac_f32 v157, v253, v173
  v_fmac_f32 v158, v253, v174
  v_fmac_f32 v159, v253, v175
  v_cvt_pk_bf16_f32 v160, v144, v145
  v_cvt_pk_bf16_f32 v161, v146, v147
  v_cvt_pk_bf16_f32 v162, v148, v149
  v_cvt_pk_bf16_f32 v163, v150, v151
  v_cvt_pk_bf16_f32 v164, v152, v153
  v_cvt_pk_bf16_f32 v165, v154, v155
  v_cvt_pk_bf16_f32 v166, v156, v157
  v_cvt_pk_bf16_f32 v167, v158, v159
  v_mfma_f32_32x32x16_bf16 v[176:191], v[160:163], v[224:227], 0
  v_mfma_f32_32x32x16_bf16 v[192:207], v[160:163], v[232:235], 0
  v_mfma_f32_32x32x16_bf16 v[176:191], v[164:167], v[228:231], v[176:191]
  v_mfma_f32_32x32x16_bf16 v[192:207], v[164:167], v[236:239], v[192:207]
  s_waitcnt lgkmcnt(3)
  v_mfma_f32_16x16x32_bf16 v[220:223], v[240:243], v[128:131], v[220:223]
  s_waitcnt lgkmcnt(2)
  v_mfma_f32_16x16x32_bf16 v[220:223], v[244:247], v[132:135], v[220:223]
  s_waitcnt lgkmcnt(1)
  v_mfma_f32_16x16x32_bf16 v[220:223], v[212:215], v[136:139], v[220:223]
  s_waitcnt lgkmcnt(0)
  v_mfma_f32_16x16x32_bf16 v[220:223], v[216:219], v[140:143], v[220:223]
  v_fma_f32 v144, -v10, v200, v176
  v_fma_f32 v152, v10, v184, v192
  v_sub_f32 v145, v177, v201
  v_add_f32 v153, v193, v185
  v_sub_f32 v146, v178, v202
  v_add_f32 v154, v194, v186
  v_sub_f32 v147, v179, v203
  v_add_f32 v155, v195, v187
  v_sub_f32 v148, v180, v204
  v_add_f32 v156, v196, v188
  v_sub_f32 v149, v181, v205
  v_add_f32 v157, v197, v189
  v_sub_f32 v150, v182, v206
  v_add_f32 v158, v198, v190
  v_sub_f32 v151, v183, v207
  v_add_f32 v159, v199, v191
  v_cvt_pk_bf16_f32 v160, v144, v145
  v_cvt_pk_bf16_f32 v161, v146, v147
  v_cvt_pk_bf16_f32 v162, v148, v149
  v_cvt_pk_bf16_f32 v163, v150, v151
  v_cvt_pk_bf16_f32 v164, v152, v153
  v_cvt_pk_bf16_f32 v165, v154, v155
  v_cvt_pk_bf16_f32 v166, v156, v157
  v_cvt_pk_bf16_f32 v167, v158, v159
  s_mov_b32 exec_hi, 0
  v_cvt_pk_bf16_f32 v12, v184, v200
  s_mov_b32 exec_hi, -1
  s_mov_b32 vcc_lo, 0x33333333
  s_mov_b32 vcc_hi, 0x33333333
  v_cndmask_b32_dpp v168, v164, v160, vcc quad_perm:[2,3,0,1] row_mask:0xf bank_mask:0xf
  v_cndmask_b32_dpp v169, v165, v161, vcc quad_perm:[2,3,0,1] row_mask:0xf bank_mask:0xf
  v_cndmask_b32_dpp v170, v166, v162, vcc quad_perm:[2,3,0,1] row_mask:0xf bank_mask:0xf
  v_cndmask_b32_dpp v171, v167, v163, vcc quad_perm:[2,3,0,1] row_mask:0xf bank_mask:0xf
  s_not_b64 vcc, vcc
  v_cndmask_b32_dpp v164, v160, v164, vcc quad_perm:[2,3,0,1] row_mask:0xf bank_mask:0xf
  v_cndmask_b32_dpp v165, v161, v165, vcc quad_perm:[2,3,0,1] row_mask:0xf bank_mask:0xf
  v_cndmask_b32_dpp v166, v162, v166, vcc quad_perm:[2,3,0,1] row_mask:0xf bank_mask:0xf
  v_cndmask_b32_dpp v167, v163, v167, vcc quad_perm:[2,3,0,1] row_mask:0xf bank_mask:0xf
  v_permlane32_swap_b32 v168, v164
  v_permlane32_swap_b32 v169, v165
  v_permlane32_swap_b32 v170, v166
  v_permlane32_swap_b32 v171, v167
  s_mov_b32 vcc_lo, 0x55555555
  s_mov_b32 vcc_hi, 0x55555555
  v_cndmask_b32_dpp v160, v164, v168, vcc quad_perm:[1,0,3,2] row_mask:0xf bank_mask:0xf
  v_cndmask_b32_dpp v161, v165, v169, vcc quad_perm:[1,0,3,2] row_mask:0xf bank_mask:0xf
  v_cndmask_b32_dpp v162, v166, v170, vcc quad_perm:[1,0,3,2] row_mask:0xf bank_mask:0xf
  v_cndmask_b32_dpp v163, v167, v171, vcc quad_perm:[1,0,3,2] row_mask:0xf bank_mask:0xf
  s_not_b64 vcc, vcc
  v_cndmask_b32_dpp v164, v168, v164, vcc quad_perm:[1,0,3,2] row_mask:0xf bank_mask:0xf
  v_cndmask_b32_dpp v165, v169, v165, vcc quad_perm:[1,0,3,2] row_mask:0xf bank_mask:0xf
  v_cndmask_b32_dpp v166, v170, v166, vcc quad_perm:[1,0,3,2] row_mask:0xf bank_mask:0xf
  v_cndmask_b32_dpp v167, v171, v167, vcc quad_perm:[1,0,3,2] row_mask:0xf bank_mask:0xf
  buffer_store_dwordx4 v[160:163], v15, s[36:39], s11 offen sc1
  buffer_store_dwordx4 v[164:167], v15, s[36:39], s12 offen sc1
  buffer_store_dword v12, v255, s[36:39], 0 offen sc1
  s_mov_b32 m0, s14
  s_mov_b64 exec, 1
  buffer_load_dword off, s[28:31], s30 offset:848 lds
  s_mov_b64 exec, -1
  s_mov_b32 vcc_lo, 0xffff0000
  s_mov_b32 vcc_hi, 0xffff0000
  v_cndmask_b32 v252, v220, v221, vcc
  ds_read_b32 v3, v1 offset:256
  s_waitcnt lgkmcnt(0)
  v_cmp_ne_u32 vcc, 0, v3
  s_cbranch_vccnz slow_g256
back_g256:
  ds_read_b64_tr_b16 v[176:177], v8 offset:0
  ds_read_b64_tr_b16 v[178:179], v8 offset:512
  ds_read_b64_tr_b16 v[180:181], v9 offset:0
  ds_read_b64_tr_b16 v[182:183], v9 offset:512
  ds_read_b64_tr_b16 v[184:185], v8 offset:1024
  ds_read_b64_tr_b16 v[186:187], v8 offset:1536
  ds_read_b64_tr_b16 v[188:189], v9 offset:1024
  ds_read_b64_tr_b16 v[190:191], v9 offset:1536
  ds_read_b64_tr_b16 v[192:193], v8 offset:2048
  ds_read_b64_tr_b16 v[194:195], v8 offset:2560
  ds_read_b32 v3, v1 offset:272
  ds_read_b64_tr_b16 v[196:197], v9 offset:2048
  ds_read_b64_tr_b16 v[198:199], v9 offset:2560
  s_waitcnt lgkmcnt(11)
  v_mfma_f32_32x32x16_bf16 v[208:223], v[176:179], v[16:19], 0
  s_waitcnt lgkmcnt(9)
  ds_read_b64_tr_b16 v[200:201], v8 offset:3072
  ds_read_b64_tr_b16 v[202:203], v8 offset:3584
  v_mfma_f32_32x32x16_bf16 v[224:239], v[180:183], v[16:19], 0
  s_waitcnt lgkmcnt(4)
  ds_read_b64_tr_b16 v[204:205], v9 offset:3072
  ds_read_b64_tr_b16 v[206:207], v9 offset:3584
  v_cmp_ne_u32 vcc, 0, v3
  v_mfma_f32_32x32x16_bf16 v[208:223], v[184:187], v[20:23], v[208:223]
  s_cbranch_vccnz slow_g272
back_g272:
  ds_read_b64_tr_b16 v[176:177], v8 offset:8192
  ds_read_b64_tr_b16 v[178:179], v8 offset:8704
  v_cvt_pk_bf16_f32 v252, v252, v252
  v_lshlrev_b32 v252, 16, v252
  v_mul_f32 v252, s15, v252
  v_mfma_f32_32x32x16_bf16 v[224:239], v[188:191], v[20:23], v[224:239]
  ds_read_b64_tr_b16 v[180:181], v9 offset:8192
  ds_read_b64_tr_b16 v[182:183], v9 offset:8704
  v_exp_f32 v252, v252
  v_mfma_f32_32x32x16_bf16 v[208:223], v[192:195], v[24:27], v[208:223]
  s_waitcnt lgkmcnt(8)
  ds_read_b64_tr_b16 v[184:185], v8 offset:9216
  ds_read_b64_tr_b16 v[186:187], v8 offset:9728
  v_mov_b32 v10, 2
  v_add_f32 v252, 1.0, v252
  v_mfma_f32_32x32x16_bf16 v[224:239], v[196:199], v[24:27], v[224:239]
  s_waitcnt lgkmcnt(8)
  ds_read_b64_tr_b16 v[188:189], v9 offset:9216
  ds_read_b64_tr_b16 v[190:191], v9 offset:9728
  v_rcp_f32 v252, v252
s_nop 0
  v_cvt_pk_bf16_f32 v252, v252, v252
  v_mfma_f32_32x32x16_bf16 v[208:223], v[200:203], v[28:31], v[208:223]
  s_waitcnt lgkmcnt(8)
  ds_read_b64_tr_b16 v[192:193], v8 offset:10240
  ds_read_b64_tr_b16 v[194:195], v8 offset:10752
  ds_read_b32 v3, v1 offset:288
  v_lshlrev_b32 v252, 16, v252
  s_lshl_b32 s3, s60, 8
  v_mfma_f32_32x32x16_bf16 v[224:239], v[204:207], v[28:31], v[224:239]
  s_waitcnt lgkmcnt(9)
  ds_read_b64_tr_b16 v[196:197], v9 offset:10240
  ds_read_b64_tr_b16 v[198:199], v9 offset:10752
  s_add_u32 s3, s3, 161792
  v_lshl_add_u32 v254, v0, 2, s3
  v_mfma_f32_32x32x16_bf16 v[208:223], v[176:179], v[32:35], v[208:223]
  s_waitcnt lgkmcnt(9)
  ds_read_b64_tr_b16 v[200:201], v8 offset:11264
  ds_read_b64_tr_b16 v[202:203], v8 offset:11776
  v_mfma_f32_32x32x16_bf16 v[224:239], v[180:183], v[32:35], v[224:239]
  s_waitcnt lgkmcnt(4)
  ds_read_b64_tr_b16 v[204:205], v9 offset:11264
  ds_read_b64_tr_b16 v[206:207], v9 offset:11776
  v_cmp_ne_u32 vcc, 0, v3
  v_mfma_f32_32x32x16_bf16 v[208:223], v[184:187], v[36:39], v[208:223]
  s_cbranch_vccnz slow_g288
back_g288:
  ds_read_b64_tr_b16 v[176:177], v8 offset:16384
  ds_read_b64_tr_b16 v[178:179], v8 offset:16896
  v_add_u32 v11, 0x1000, v2
  s_add_u32 s3, s64, 1
  s_lshl_b32 s3, s3, 30
  s_and_b32 s3, s3, 0x80000000
  v_or_b32 v251, s3, v11
  v_mfma_f32_32x32x16_bf16 v[224:239], v[188:191], v[36:39], v[224:239]
  ds_read_b64_tr_b16 v[180:181], v9 offset:16384
  ds_read_b64_tr_b16 v[182:183], v9 offset:16896
  v_mfma_f32_32x32x16_bf16 v[208:223], v[192:195], v[40:43], v[208:223]
  s_waitcnt lgkmcnt(8)
  ds_read_b64_tr_b16 v[184:185], v8 offset:17408
  ds_read_b64_tr_b16 v[186:187], v8 offset:17920
  v_bfe_u32 v240, v0, 2, 2
  v_lshrrev_b32 v241, 5, v0
  v_mfma_f32_32x32x16_bf16 v[224:239], v[196:199], v[40:43], v[224:239]
  s_waitcnt lgkmcnt(8)
  ds_read_b64_tr_b16 v[188:189], v9 offset:17408
  ds_read_b64_tr_b16 v[190:191], v9 offset:17920
  v_lshl_add_u32 v241, v241, 2, v240
  v_lshlrev_b32 v241, 8, v241
  v_mfma_f32_32x32x16_bf16 v[208:223], v[200:203], v[44:47], v[208:223]
  s_waitcnt lgkmcnt(8)
  ds_read_b64_tr_b16 v[192:193], v8 offset:18432
  ds_read_b64_tr_b16 v[194:195], v8 offset:18944
  ds_read_b32 v3, v1 offset:304
  v_and_b32 v242, 16, v0
  v_add_u32 v242, v242, v14
  v_mfma_f32_32x32x16_bf16 v[224:239], v[204:207], v[44:47], v[224:239]
  s_waitcnt lgkmcnt(9)
  ds_read_b64_tr_b16 v[196:197], v9 offset:18432
  ds_read_b64_tr_b16 v[198:199], v9 offset:18944
  v_lshl_add_u32 v241, v242, 1, v241
  v_add_u32 v241, 131072, v241
  v_mfma_f32_32x32x16_bf16 v[208:223], v[176:179], v[48:51], v[208:223]
  s_waitcnt lgkmcnt(9)
  ds_read_b64_tr_b16 v[200:201], v8 offset:19456
  ds_read_b64_tr_b16 v[202:203], v8 offset:19968
  v_xor_b32 v242, 0, v240
  v_lshl_add_u32 v4, v242, 6, v241
  v_mfma_f32_32x32x16_bf16 v[224:239], v[180:183], v[48:51], v[224:239]
  s_waitcnt lgkmcnt(4)
  ds_read_b64_tr_b16 v[204:205], v9 offset:19456
  ds_read_b64_tr_b16 v[206:207], v9 offset:19968
  v_cmp_ne_u32 vcc, 0, v3
  v_xor_b32 v242, 1, v240
  v_lshl_add_u32 v5, v242, 6, v241
  v_mfma_f32_32x32x16_bf16 v[208:223], v[184:187], v[52:55], v[208:223]
  s_cbranch_vccnz slow_g304
back_g304:
  ds_read_b64_tr_b16 v[176:177], v8 offset:24576
  ds_read_b64_tr_b16 v[178:179], v8 offset:25088
  v_xor_b32 v242, 2, v240
  v_lshl_add_u32 v6, v242, 6, v241
  v_mfma_f32_32x32x16_bf16 v[224:239], v[188:191], v[52:55], v[224:239]
  ds_read_b64_tr_b16 v[180:181], v9 offset:24576
  ds_read_b64_tr_b16 v[182:183], v9 offset:25088
  v_xor_b32 v242, 3, v240
  v_lshl_add_u32 v7, v242, 6, v241
  v_mfma_f32_32x32x16_bf16 v[208:223], v[192:195], v[56:59], v[208:223]
  s_waitcnt lgkmcnt(8)
  ds_read_b64_tr_b16 v[184:185], v8 offset:25600
  ds_read_b64_tr_b16 v[186:187], v8 offset:26112
  v_mfma_f32_32x32x16_bf16 v[224:239], v[196:199], v[56:59], v[224:239]
  s_waitcnt lgkmcnt(8)
  ds_read_b64_tr_b16 v[188:189], v9 offset:25600
  ds_read_b64_tr_b16 v[190:191], v9 offset:26112
  v_mfma_f32_32x32x16_bf16 v[208:223], v[200:203], v[60:63], v[208:223]
  s_waitcnt lgkmcnt(8)
  ds_read_b64_tr_b16 v[192:193], v8 offset:26624
  ds_read_b64_tr_b16 v[194:195], v8 offset:27136
  ds_read_b32 v3, v1 offset:320
  v_mfma_f32_32x32x16_bf16 v[224:239], v[204:207], v[60:63], v[224:239]
  s_waitcnt lgkmcnt(9)
  ds_read_b64_tr_b16 v[196:197], v9 offset:26624
  ds_read_b64_tr_b16 v[198:199], v9 offset:27136
  v_mfma_f32_32x32x16_bf16 v[208:223], v[176:179], v[64:67], v[208:223]
  s_waitcnt lgkmcnt(9)
  ds_read_b64_tr_b16 v[200:201], v8 offset:27648
  ds_read_b64_tr_b16 v[202:203], v8 offset:28160
  v_mfma_f32_32x32x16_bf16 v[224:239], v[180:183], v[64:67], v[224:239]
  s_waitcnt lgkmcnt(4)
  ds_read_b64_tr_b16 v[204:205], v9 offset:27648
  ds_read_b64_tr_b16 v[206:207], v9 offset:28160
  v_cmp_ne_u32 vcc, 0, v3
  v_mfma_f32_32x32x16_bf16 v[208:223], v[184:187], v[68:71], v[208:223]
  s_cbranch_vccnz slow_g320
back_g320:
  ds_read_b64_tr_b16 v[176:177], v8 offset:32768
  ds_read_b64_tr_b16 v[178:179], v8 offset:33280
  v_mfma_f32_32x32x16_bf16 v[224:239], v[188:191], v[68:71], v[224:239]
  ds_read_b64_tr_b16 v[180:181], v9 offset:32768
  ds_read_b64_tr_b16 v[182:183], v9 offset:33280
  v_mfma_f32_32x32x16_bf16 v[208:223], v[192:195], v[72:75], v[208:223]
  s_waitcnt lgkmcnt(8)
  ds_read_b64_tr_b16 v[184:185], v8 offset:33792
  ds_read_b64_tr_b16 v[186:187], v8 offset:34304
  v_mfma_f32_32x32x16_bf16 v[224:239], v[196:199], v[72:75], v[224:239]
  s_waitcnt lgkmcnt(8)
  ds_read_b64_tr_b16 v[188:189], v9 offset:33792
  ds_read_b64_tr_b16 v[190:191], v9 offset:34304
  v_mfma_f32_32x32x16_bf16 v[208:223], v[200:203], v[76:79], v[208:223]
  s_waitcnt lgkmcnt(8)
  ds_read_b64_tr_b16 v[192:193], v8 offset:34816
  ds_read_b64_tr_b16 v[194:195], v8 offset:35328
  ds_read_b32 v3, v1 offset:336
  s_buffer_load_dword s46, s[36:39], s44 glc
  s_buffer_load_dword s47, s[36:39], s23 glc
  s_mov_b32 s69, s68
  v_mfma_f32_32x32x16_bf16 v[224:239], v[204:207], v[76:79], v[224:239]
  s_waitcnt lgkmcnt(9)
  ds_read_b64_tr_b16 v[196:197], v9 offset:34816
  ds_read_b64_tr_b16 v[198:199], v9 offset:35328
  s_mov_b64 s[48:49], 0
  s_mov_b64 s[50:51], 0
  v_mfma_f32_32x32x16_bf16 v[208:223], v[176:179], v[80:83], v[208:223]
  s_waitcnt lgkmcnt(9)
  ds_read_b64_tr_b16 v[200:201], v8 offset:35840
  ds_read_b64_tr_b16 v[202:203], v8 offset:36352
  s_mov_b64 s[52:53], 0
  s_mov_b64 s[54:55], 0
  v_mfma_f32_32x32x16_bf16 v[224:239], v[180:183], v[80:83], v[224:239]
  s_waitcnt lgkmcnt(4)
  ds_read_b64_tr_b16 v[204:205], v9 offset:35840
  ds_read_b64_tr_b16 v[206:207], v9 offset:36352
  v_cmp_ne_u32 vcc, 0, v3
  s_mov_b64 s[56:57], 0
  s_mov_b64 s[58:59], 0
  v_mfma_f32_32x32x16_bf16 v[208:223], v[184:187], v[84:87], v[208:223]
  s_cbranch_vccnz slow_g336
back_g336:
  ds_read_b64_tr_b16 v[176:177], v8 offset:40960
  ds_read_b64_tr_b16 v[178:179], v8 offset:41472
  s_mov_b64 s[32:33], 0
  s_mov_b64 s[34:35], 0
  v_mfma_f32_32x32x16_bf16 v[224:239], v[188:191], v[84:87], v[224:239]
  ds_read_b64_tr_b16 v[180:181], v9 offset:40960
  ds_read_b64_tr_b16 v[182:183], v9 offset:41472
  v_mfma_f32_32x32x16_bf16 v[208:223], v[192:195], v[88:91], v[208:223]
  s_waitcnt lgkmcnt(8)
  ds_read_b64_tr_b16 v[184:185], v8 offset:41984
  ds_read_b64_tr_b16 v[186:187], v8 offset:42496
  v_mfma_f32_32x32x16_bf16 v[224:239], v[196:199], v[88:91], v[224:239]
  s_waitcnt lgkmcnt(8)
  ds_read_b64_tr_b16 v[188:189], v9 offset:41984
  ds_read_b64_tr_b16 v[190:191], v9 offset:42496
  v_mfma_f32_32x32x16_bf16 v[208:223], v[200:203], v[92:95], v[208:223]
  s_waitcnt lgkmcnt(8)
  ds_read_b64_tr_b16 v[192:193], v8 offset:43008
  ds_read_b64_tr_b16 v[194:195], v8 offset:43520
  ds_read_b32 v3, v1 offset:352
  v_mfma_f32_32x32x16_bf16 v[224:239], v[204:207], v[92:95], v[224:239]
  s_waitcnt lgkmcnt(9)
  ds_read_b64_tr_b16 v[196:197], v9 offset:43008
  ds_read_b64_tr_b16 v[198:199], v9 offset:43520
  v_mfma_f32_32x32x16_bf16 v[208:223], v[176:179], v[96:99], v[208:223]
  s_waitcnt lgkmcnt(9)
  ds_read_b64_tr_b16 v[200:201], v8 offset:44032
  ds_read_b64_tr_b16 v[202:203], v8 offset:44544
  v_mfma_f32_32x32x16_bf16 v[224:239], v[180:183], v[96:99], v[224:239]
  s_waitcnt lgkmcnt(4)
  ds_read_b64_tr_b16 v[204:205], v9 offset:44032
  ds_read_b64_tr_b16 v[206:207], v9 offset:44544
  v_cmp_ne_u32 vcc, 0, v3
  v_mfma_f32_32x32x16_bf16 v[208:223], v[184:187], v[100:103], v[208:223]
  s_cbranch_vccnz slow_g352
back_g352:
  ds_read_b64_tr_b16 v[176:177], v8 offset:49152
  ds_read_b64_tr_b16 v[178:179], v8 offset:49664
  v_mfma_f32_32x32x16_bf16 v[224:239], v[188:191], v[100:103], v[224:239]
  ds_read_b64_tr_b16 v[180:181], v9 offset:49152
  ds_read_b64_tr_b16 v[182:183], v9 offset:49664
  v_mfma_f32_32x32x16_bf16 v[208:223], v[192:195], v[104:107], v[208:223]
  s_waitcnt lgkmcnt(8)
  ds_read_b64_tr_b16 v[184:185], v8 offset:50176
  ds_read_b64_tr_b16 v[186:187], v8 offset:50688
  v_mfma_f32_32x32x16_bf16 v[224:239], v[196:199], v[104:107], v[224:239]
  s_waitcnt lgkmcnt(8)
  ds_read_b64_tr_b16 v[188:189], v9 offset:50176
  ds_read_b64_tr_b16 v[190:191], v9 offset:50688
  v_mfma_f32_32x32x16_bf16 v[208:223], v[200:203], v[108:111], v[208:223]
  s_waitcnt lgkmcnt(8)
  ds_read_b64_tr_b16 v[192:193], v8 offset:51200
  ds_read_b64_tr_b16 v[194:195], v8 offset:51712
  ds_read_b32 v3, v1 offset:368
  v_mfma_f32_32x32x16_bf16 v[224:239], v[204:207], v[108:111], v[224:239]
  s_waitcnt lgkmcnt(9)
  ds_read_b64_tr_b16 v[196:197], v9 offset:51200
  ds_read_b64_tr_b16 v[198:199], v9 offset:51712
  v_mfma_f32_32x32x16_bf16 v[208:223], v[176:179], v[112:115], v[208:223]
  s_waitcnt lgkmcnt(9)
  ds_read_b64_tr_b16 v[200:201], v8 offset:52224
  ds_read_b64_tr_b16 v[202:203], v8 offset:52736
  v_mfma_f32_32x32x16_bf16 v[224:239], v[180:183], v[112:115], v[224:239]
  s_waitcnt lgkmcnt(4)
  ds_read_b64_tr_b16 v[204:205], v9 offset:52224
  ds_read_b64_tr_b16 v[206:207], v9 offset:52736
  v_cmp_ne_u32 vcc, 0, v3
  v_mfma_f32_32x32x16_bf16 v[208:223], v[184:187], v[116:119], v[208:223]
  s_cbranch_vccnz slow_g368
back_g368:
  ds_read_b64_tr_b16 v[176:177], v8 offset:57344
  ds_read_b64_tr_b16 v[178:179], v8 offset:57856
  v_mfma_f32_32x32x16_bf16 v[224:239], v[188:191], v[116:119], v[224:239]
  ds_read_b64_tr_b16 v[180:181], v9 offset:57344
  ds_read_b64_tr_b16 v[182:183], v9 offset:57856
  v_mfma_f32_32x32x16_bf16 v[208:223], v[192:195], v[120:123], v[208:223]
  s_waitcnt lgkmcnt(8)
  ds_read_b64_tr_b16 v[184:185], v8 offset:58368
  ds_read_b64_tr_b16 v[186:187], v8 offset:58880
  v_mfma_f32_32x32x16_bf16 v[224:239], v[196:199], v[120:123], v[224:239]
  s_waitcnt lgkmcnt(8)
  ds_read_b64_tr_b16 v[188:189], v9 offset:58368
  ds_read_b64_tr_b16 v[190:191], v9 offset:58880
  v_mfma_f32_32x32x16_bf16 v[208:223], v[200:203], v[124:127], v[208:223]
  s_waitcnt lgkmcnt(8)
  ds_read_b64_tr_b16 v[192:193], v8 offset:59392
  ds_read_b64_tr_b16 v[194:195], v8 offset:59904
  v_mfma_f32_32x32x16_bf16 v[224:239], v[204:207], v[124:127], v[224:239]
  s_waitcnt lgkmcnt(8)
  ds_read_b64_tr_b16 v[196:197], v9 offset:59392
  ds_read_b64_tr_b16 v[198:199], v9 offset:59904
  v_mfma_f32_32x32x16_bf16 v[208:223], v[176:179], v[128:131], v[208:223]
  s_waitcnt lgkmcnt(8)
  ds_read_b64_tr_b16 v[200:201], v8 offset:60416
  ds_read_b64_tr_b16 v[202:203], v8 offset:60928
  v_mfma_f32_32x32x16_bf16 v[224:239], v[180:183], v[128:131], v[224:239]
  s_waitcnt lgkmcnt(8)
  ds_read_b64_tr_b16 v[204:205], v9 offset:60416
  ds_read_b64_tr_b16 v[206:207], v9 offset:60928
  v_add_u32 v8, 0x10000, v8
  v_add_u32 v9, 0x10000, v9
  v_mfma_f32_32x32x16_bf16 v[208:223], v[184:187], v[132:135], v[208:223]
  s_waitcnt lgkmcnt(8)
  ds_read_b64_tr_b16 v[176:177], v8 offset:49152
  ds_read_b64_tr_b16 v[178:179], v8 offset:49664
  ds_read_b32 v3, v1 offset:384
  v_mfma_f32_32x32x16_bf16 v[224:239], v[188:191], v[132:135], v[224:239]
  s_waitcnt lgkmcnt(9)
  ds_read_b64_tr_b16 v[180:181], v8 offset:50176
  ds_read_b64_tr_b16 v[182:183], v8 offset:50688
  v_mfma_f32_32x32x16_bf16 v[208:223], v[192:195], v[136:139], v[208:223]
  s_waitcnt lgkmcnt(9)
  ds_read_b64_tr_b16 v[184:185], v8 offset:51200
  ds_read_b64_tr_b16 v[186:187], v8 offset:51712
  v_mfma_f32_32x32x16_bf16 v[224:239], v[196:199], v[136:139], v[224:239]
  s_waitcnt lgkmcnt(4)
  ds_read_b64_tr_b16 v[188:189], v8 offset:52224
  ds_read_b64_tr_b16 v[190:191], v8 offset:52736
  v_cmp_ne_u32 vcc, 0, v3
  v_mfma_f32_32x32x16_bf16 v[208:223], v[200:203], v[140:143], v[208:223]
  s_cbranch_vccnz slow_g384
back_g384:
  ds_read_b64_tr_b16 v[192:193], v8 offset:57344
  ds_read_b64_tr_b16 v[194:195], v8 offset:57856
  s_mov_b32 m0, s14
  s_mov_b64 exec, 1
  buffer_load_dword off, s[28:31], s30 offset:1008 lds
  s_mov_b64 exec, -1
  v_mfma_f32_32x32x16_bf16 v[224:239], v[204:207], v[140:143], v[224:239]
  ds_read_b64_tr_b16 v[196:197], v8 offset:58368
  ds_read_b64_tr_b16 v[198:199], v8 offset:58880
  v_mfma_f32_32x32x16_bf16 v[144:159], v[176:179], v[16:19], 0
  s_waitcnt lgkmcnt(8)
  ds_read_b64_tr_b16 v[200:201], v8 offset:59392
  ds_read_b64_tr_b16 v[202:203], v8 offset:59904
  v_mul_f32 v240, s15, v208
  v_mul_f32 v241, s15, v209
  v_mul_f32 v242, s15, v210
  v_mul_f32 v243, s15, v211
  v_exp_f32 v240, v240
  v_exp_f32 v241, v241
  v_mfma_f32_32x32x16_bf16 v[144:159], v[180:183], v[20:23], v[144:159]
  s_waitcnt lgkmcnt(8)
  ds_read_b64_tr_b16 v[204:205], v8 offset:60416
  ds_read_b64_tr_b16 v[206:207], v8 offset:60928
  v_exp_f32 v242, v242
  v_exp_f32 v243, v243
  v_add_f32 v240, 1.0, v240
  v_add_f32 v241, 1.0, v241
  v_add_f32 v242, 1.0, v242
  v_add_f32 v243, 1.0, v243
  v_mfma_f32_32x32x16_bf16 v[144:159], v[184:187], v[24:27], v[144:159]
  s_waitcnt lgkmcnt(8)
  ds_read_b64_tr_b16 v[176:177], v8 offset:0
  ds_read_b64_tr_b16 v[178:179], v8 offset:512
  ds_read_b32 v3, v1 offset:400
  v_rcp_f32 v240, v240
  v_rcp_f32 v241, v241
  v_rcp_f32 v242, v242
  v_rcp_f32 v243, v243
  v_mfma_f32_32x32x16_bf16 v[144:159], v[188:191], v[28:31], v[144:159]
  s_waitcnt lgkmcnt(9)
  ds_read_b64_tr_b16 v[180:181], v8 offset:1024
  ds_read_b64_tr_b16 v[182:183], v8 offset:1536
  v_mul_f32 v240, v240, v208
  v_mul_f32 v241, v241, v209
  v_mul_f32 v242, v242, v210
  v_mul_f32 v243, v243, v211
  v_cvt_pk_bf16_f32 v208, v240, v241
  v_cvt_pk_bf16_f32 v209, v242, v243
  v_mul_f32 v244, s15, v212
  v_mfma_f32_32x32x16_bf16 v[144:159], v[192:195], v[32:35], v[144:159]
  s_waitcnt lgkmcnt(9)
  ds_read_b64_tr_b16 v[184:185], v8 offset:2048
  ds_read_b64_tr_b16 v[186:187], v8 offset:2560
  v_mul_f32 v245, s15, v213
  v_mul_f32 v246, s15, v214
  v_mul_f32 v247, s15, v215
  v_exp_f32 v244, v244
  v_exp_f32 v245, v245
  v_exp_f32 v246, v246
  v_mfma_f32_32x32x16_bf16 v[144:159], v[196:199], v[36:39], v[144:159]
  s_waitcnt lgkmcnt(4)
  ds_read_b64_tr_b16 v[188:189], v8 offset:3072
  ds_read_b64_tr_b16 v[190:191], v8 offset:3584
  v_cmp_ne_u32 vcc, 0, v3
  v_exp_f32 v247, v247
  v_add_f32 v244, 1.0, v244
  v_add_f32 v245, 1.0, v245
  v_add_f32 v246, 1.0, v246
  v_add_f32 v247, 1.0, v247
  v_mfma_f32_32x32x16_bf16 v[144:159], v[200:203], v[40:43], v[144:159]
  s_cbranch_vccnz slow_g400
back_g400:
  ds_read_b64_tr_b16 v[192:193], v8 offset:8192
  ds_read_b64_tr_b16 v[194:195], v8 offset:8704
  v_rcp_f32 v244, v244
  v_rcp_f32 v245, v245
  v_rcp_f32 v246, v246
  v_rcp_f32 v247, v247
  v_mfma_f32_32x32x16_bf16 v[144:159], v[204:207], v[44:47], v[144:159]
  ds_read_b64_tr_b16 v[196:197], v8 offset:9216
  ds_read_b64_tr_b16 v[198:199], v8 offset:9728
  v_mul_f32 v244, v244, v212
  v_mul_f32 v245, v245, v213
  v_mul_f32 v246, v246, v214
  v_mul_f32 v247, v247, v215
  v_cvt_pk_bf16_f32 v210, v244, v245
  v_cvt_pk_bf16_f32 v211, v246, v247
  buffer_store_dwordx4 v[208:211], v2, s[36:39], s16 offen offset:0 sc1
  v_mfma_f32_32x32x16_bf16 v[144:159], v[176:179], v[48:51], v[144:159]
  s_waitcnt lgkmcnt(8)
  ds_read_b64_tr_b16 v[200:201], v8 offset:10240
  ds_read_b64_tr_b16 v[202:203], v8 offset:10752
  v_mul_f32 v240, s15, v216
  v_mul_f32 v241, s15, v217
  v_mul_f32 v242, s15, v218
  v_mul_f32 v243, s15, v219
  v_exp_f32 v240, v240
  v_exp_f32 v241, v241
  v_mfma_f32_32x32x16_bf16 v[144:159], v[180:183], v[52:55], v[144:159]
  s_waitcnt lgkmcnt(8)
  ds_read_b64_tr_b16 v[204:205], v8 offset:11264
  ds_read_b64_tr_b16 v[206:207], v8 offset:11776
  v_exp_f32 v242, v242
  v_exp_f32 v243, v243
  v_add_f32 v240, 1.0, v240
  v_add_f32 v241, 1.0, v241
  v_add_f32 v242, 1.0, v242
  v_add_f32 v243, 1.0, v243
  v_mfma_f32_32x32x16_bf16 v[144:159], v[184:187], v[56:59], v[144:159]
  s_waitcnt lgkmcnt(8)
  ds_read_b64_tr_b16 v[176:177], v8 offset:16384
  ds_read_b64_tr_b16 v[178:179], v8 offset:16896
  ds_read_b32 v3, v1 offset:416
  v_rcp_f32 v240, v240
  v_rcp_f32 v241, v241
  v_rcp_f32 v242, v242
  v_rcp_f32 v243, v243
  v_mfma_f32_32x32x16_bf16 v[144:159], v[188:191], v[60:63], v[144:159]
  s_waitcnt lgkmcnt(9)
  ds_read_b64_tr_b16 v[180:181], v8 offset:17408
  ds_read_b64_tr_b16 v[182:183], v8 offset:17920
  v_mul_f32 v240, v240, v216
  v_mul_f32 v241, v241, v217
  v_mul_f32 v242, v242, v218
  v_mul_f32 v243, v243, v219
  v_cvt_pk_bf16_f32 v212, v240, v241
  v_cvt_pk_bf16_f32 v213, v242, v243
  v_mul_f32 v244, s15, v220
  v_mfma_f32_32x32x16_bf16 v[144:159], v[192:195], v[64:67], v[144:159]
  s_waitcnt lgkmcnt(9)
  ds_read_b64_tr_b16 v[184:185], v8 offset:18432
  ds_read_b64_tr_b16 v[186:187], v8 offset:18944
  v_mul_f32 v245, s15, v221
  v_mul_f32 v246, s15, v222
  v_mul_f32 v247, s15, v223
  v_exp_f32 v244, v244
  v_exp_f32 v245, v245
  v_exp_f32 v246, v246
  v_mfma_f32_32x32x16_bf16 v[144:159], v[196:199], v[68:71], v[144:159]
  s_waitcnt lgkmcnt(4)
  ds_read_b64_tr_b16 v[188:189], v8 offset:19456
  ds_read_b64_tr_b16 v[190:191], v8 offset:19968
  v_cmp_ne_u32 vcc, 0, v3
  v_exp_f32 v247, v247
  v_add_f32 v244, 1.0, v244
  v_add_f32 v245, 1.0, v245
  v_add_f32 v246, 1.0, v246
  v_add_f32 v247, 1.0, v247
  v_mfma_f32_32x32x16_bf16 v[144:159], v[200:203], v[72:75], v[144:159]
  s_cbranch_vccnz slow_g416
back_g416:
  ds_read_b64_tr_b16 v[192:193], v8 offset:24576
  ds_read_b64_tr_b16 v[194:195], v8 offset:25088
  v_rcp_f32 v244, v244
  v_rcp_f32 v245, v245
  v_rcp_f32 v246, v246
  v_rcp_f32 v247, v247
  v_mfma_f32_32x32x16_bf16 v[144:159], v[204:207], v[76:79], v[144:159]
  ds_read_b64_tr_b16 v[196:197], v8 offset:25600
  ds_read_b64_tr_b16 v[198:199], v8 offset:26112
  v_mul_f32 v244, v244, v220
  v_mul_f32 v245, v245, v221
  v_mul_f32 v246, v246, v222
  v_mul_f32 v247, v247, v223
  v_cvt_pk_bf16_f32 v214, v244, v245
  v_cvt_pk_bf16_f32 v215, v246, v247
  buffer_store_dwordx4 v[212:215], v2, s[36:39], s16 offen offset:1024 sc1
  v_mfma_f32_32x32x16_bf16 v[144:159], v[176:179], v[80:83], v[144:159]
  s_waitcnt lgkmcnt(8)
  ds_read_b64_tr_b16 v[200:201], v8 offset:26624
  ds_read_b64_tr_b16 v[202:203], v8 offset:27136
  v_mul_f32 v240, s15, v224
  v_mul_f32 v241, s15, v225
  v_mul_f32 v242, s15, v226
  v_mul_f32 v243, s15, v227
  v_exp_f32 v240, v240
  v_exp_f32 v241, v241
  v_mfma_f32_32x32x16_bf16 v[144:159], v[180:183], v[84:87], v[144:159]
  s_waitcnt lgkmcnt(8)
  ds_read_b64_tr_b16 v[204:205], v8 offset:27648
  ds_read_b64_tr_b16 v[206:207], v8 offset:28160
  v_exp_f32 v242, v242
  v_exp_f32 v243, v243
  v_add_f32 v240, 1.0, v240
  v_add_f32 v241, 1.0, v241
  v_add_f32 v242, 1.0, v242
  v_add_f32 v243, 1.0, v243
  v_mfma_f32_32x32x16_bf16 v[144:159], v[184:187], v[88:91], v[144:159]
  s_waitcnt lgkmcnt(8)
  ds_read_b64_tr_b16 v[176:177], v8 offset:32768
  ds_read_b64_tr_b16 v[178:179], v8 offset:33280
  ds_read_b32 v3, v1 offset:432
  v_rcp_f32 v240, v240
  v_rcp_f32 v241, v241
  v_rcp_f32 v242, v242
  v_rcp_f32 v243, v243
  v_mfma_f32_32x32x16_bf16 v[144:159], v[188:191], v[92:95], v[144:159]
  s_waitcnt lgkmcnt(9)
  ds_read_b64_tr_b16 v[180:181], v8 offset:33792
  ds_read_b64_tr_b16 v[182:183], v8 offset:34304
  v_mul_f32 v240, v240, v224
  v_mul_f32 v241, v241, v225
  v_mul_f32 v242, v242, v226
  v_mul_f32 v243, v243, v227
  v_cvt_pk_bf16_f32 v224, v240, v241
  v_cvt_pk_bf16_f32 v225, v242, v243
  v_mul_f32 v244, s15, v228
  v_mfma_f32_32x32x16_bf16 v[144:159], v[192:195], v[96:99], v[144:159]
  s_waitcnt lgkmcnt(9)
  ds_read_b64_tr_b16 v[184:185], v8 offset:34816
  ds_read_b64_tr_b16 v[186:187], v8 offset:35328
  v_mul_f32 v245, s15, v229
  v_mul_f32 v246, s15, v230
  v_mul_f32 v247, s15, v231
  v_exp_f32 v244, v244
  v_exp_f32 v245, v245
  v_exp_f32 v246, v246
  v_mfma_f32_32x32x16_bf16 v[144:159], v[196:199], v[100:103], v[144:159]
  s_waitcnt lgkmcnt(4)
  ds_read_b64_tr_b16 v[188:189], v8 offset:35840
  ds_read_b64_tr_b16 v[190:191], v8 offset:36352
  v_cmp_ne_u32 vcc, 0, v3
  v_exp_f32 v247, v247
  v_add_f32 v244, 1.0, v244
  v_add_f32 v245, 1.0, v245
  v_add_f32 v246, 1.0, v246
  v_add_f32 v247, 1.0, v247
  v_mfma_f32_32x32x16_bf16 v[144:159], v[200:203], v[104:107], v[144:159]
  s_cbranch_vccnz slow_g432
back_g432:
  ds_read_b64_tr_b16 v[192:193], v8 offset:40960
  ds_read_b64_tr_b16 v[194:195], v8 offset:41472
  v_rcp_f32 v244, v244
  v_rcp_f32 v245, v245
  v_rcp_f32 v246, v246
  v_rcp_f32 v247, v247
  v_mfma_f32_32x32x16_bf16 v[144:159], v[204:207], v[108:111], v[144:159]
  ds_read_b64_tr_b16 v[196:197], v8 offset:41984
  ds_read_b64_tr_b16 v[198:199], v8 offset:42496
  v_mul_f32 v244, v244, v228
  v_mul_f32 v245, v245, v229
  v_mul_f32 v246, v246, v230
  v_mul_f32 v247, v247, v231
  v_cvt_pk_bf16_f32 v226, v244, v245
  v_cvt_pk_bf16_f32 v227, v246, v247
  buffer_store_dwordx4 v[224:227], v2, s[36:39], s16 offen offset:2048 sc1
  v_mfma_f32_32x32x16_bf16 v[144:159], v[176:179], v[112:115], v[144:159]
  s_waitcnt lgkmcnt(8)
  ds_read_b64_tr_b16 v[200:201], v8 offset:43008
  ds_read_b64_tr_b16 v[202:203], v8 offset:43520
  v_mul_f32 v240, s15, v232
  v_mul_f32 v241, s15, v233
  v_mul_f32 v242, s15, v234
  v_mul_f32 v243, s15, v235
  v_exp_f32 v240, v240
  v_exp_f32 v241, v241
  v_mfma_f32_32x32x16_bf16 v[144:159], v[180:183], v[116:119], v[144:159]
  s_waitcnt lgkmcnt(8)
  ds_read_b64_tr_b16 v[204:205], v8 offset:44032
  ds_read_b64_tr_b16 v[206:207], v8 offset:44544
  v_exp_f32 v242, v242
  v_exp_f32 v243, v243
  v_add_f32 v240, 1.0, v240
  v_add_f32 v241, 1.0, v241
  v_add_f32 v242, 1.0, v242
  v_add_f32 v243, 1.0, v243
  v_mfma_f32_32x32x16_bf16 v[144:159], v[184:187], v[120:123], v[144:159]
  s_waitcnt lgkmcnt(8)
  ds_read_b64_tr_b16 v[176:177], v9 offset:49152
  ds_read_b64_tr_b16 v[178:179], v9 offset:49664
  v_rcp_f32 v240, v240
  v_rcp_f32 v241, v241
  v_rcp_f32 v242, v242
  v_rcp_f32 v243, v243
  v_mfma_f32_32x32x16_bf16 v[144:159], v[188:191], v[124:127], v[144:159]
  s_waitcnt lgkmcnt(8)
  ds_read_b64_tr_b16 v[180:181], v9 offset:50176
  ds_read_b64_tr_b16 v[182:183], v9 offset:50688
  v_mul_f32 v240, v240, v232
  v_mul_f32 v241, v241, v233
  v_mul_f32 v242, v242, v234
  v_mul_f32 v243, v243, v235
  v_cvt_pk_bf16_f32 v228, v240, v241
  v_cvt_pk_bf16_f32 v229, v242, v243
  v_mul_f32 v244, s15, v236
  v_mfma_f32_32x32x16_bf16 v[144:159], v[192:195], v[128:131], v[144:159]
  s_waitcnt lgkmcnt(8)
  ds_read_b64_tr_b16 v[184:185], v9 offset:51200
  ds_read_b64_tr_b16 v[186:187], v9 offset:51712
  v_mul_f32 v245, s15, v237
  v_mul_f32 v246, s15, v238
  v_mul_f32 v247, s15, v239
  v_exp_f32 v244, v244
  v_exp_f32 v245, v245
  v_exp_f32 v246, v246
  v_mfma_f32_32x32x16_bf16 v[144:159], v[196:199], v[132:135], v[144:159]
  s_waitcnt lgkmcnt(8)
  ds_read_b64_tr_b16 v[188:189], v9 offset:52224
  ds_read_b64_tr_b16 v[190:191], v9 offset:52736
  v_exp_f32 v247, v247
  v_add_f32 v244, 1.0, v244
  v_add_f32 v245, 1.0, v245
  v_add_f32 v246, 1.0, v246
  v_add_f32 v247, 1.0, v247
  v_mfma_f32_32x32x16_bf16 v[144:159], v[200:203], v[136:139], v[144:159]
  s_waitcnt lgkmcnt(8)
  ds_read_b64_tr_b16 v[192:193], v9 offset:57344
  ds_read_b64_tr_b16 v[194:195], v9 offset:57856
  v_rcp_f32 v244, v244
  v_rcp_f32 v245, v245
  v_rcp_f32 v246, v246
  v_rcp_f32 v247, v247
  v_mfma_f32_32x32x16_bf16 v[144:159], v[204:207], v[140:143], v[144:159]
  s_waitcnt lgkmcnt(8)
  ds_read_b64_tr_b16 v[196:197], v9 offset:58368
  ds_read_b64_tr_b16 v[198:199], v9 offset:58880
  v_mul_f32 v244, v244, v236
  v_mul_f32 v245, v245, v237
  v_mul_f32 v246, v246, v238
  v_mul_f32 v247, v247, v239
  v_cvt_pk_bf16_f32 v230, v244, v245
  v_cvt_pk_bf16_f32 v231, v246, v247
  buffer_store_dwordx4 v[228:231], v2, s[36:39], s16 offen offset:3072 sc1
  v_mfma_f32_32x32x16_bf16 v[160:175], v[176:179], v[16:19], 0
  s_waitcnt vmcnt(2) lgkmcnt(8)
  ds_read_b64_tr_b16 v[200:201], v9 offset:59392
  ds_read_b64_tr_b16 v[202:203], v9 offset:59904
  s_buffer_atomic_swap s68, s[36:39], s44 offset:0
  v_mfma_f32_32x32x16_bf16 v[160:175], v[180:183], v[20:23], v[160:175]
  s_waitcnt lgkmcnt(8)
  ds_read_b64_tr_b16 v[204:205], v9 offset:60416
  ds_read_b64_tr_b16 v[206:207], v9 offset:60928
  v_mul_f32 v240, s15, v144
  v_mul_f32 v241, s15, v145
  v_mul_f32 v242, s15, v146
  v_mul_f32 v243, s15, v147
  v_exp_f32 v240, v240
  v_exp_f32 v241, v241
  v_mfma_f32_32x32x16_bf16 v[160:175], v[184:187], v[24:27], v[160:175]
  s_waitcnt lgkmcnt(8)
  ds_read_b64_tr_b16 v[176:177], v9 offset:0
  ds_read_b64_tr_b16 v[178:179], v9 offset:512
  v_exp_f32 v242, v242
  v_exp_f32 v243, v243
  v_add_f32 v240, 1.0, v240
  v_mfma_f32_32x32x16_bf16 v[160:175], v[188:191], v[28:31], v[160:175]
  s_waitcnt lgkmcnt(8)
  ds_read_b64_tr_b16 v[180:181], v9 offset:1024
  ds_read_b64_tr_b16 v[182:183], v9 offset:1536
  v_add_f32 v241, 1.0, v241
  v_add_f32 v242, 1.0, v242
  v_add_f32 v243, 1.0, v243
  v_rcp_f32 v240, v240
  v_rcp_f32 v241, v241
  v_mfma_f32_32x32x16_bf16 v[160:175], v[192:195], v[32:35], v[160:175]
  s_waitcnt lgkmcnt(8)
  ds_read_b64_tr_b16 v[184:185], v9 offset:2048
  ds_read_b64_tr_b16 v[186:187], v9 offset:2560
  v_rcp_f32 v242, v242
  v_rcp_f32 v243, v243
  v_mul_f32 v240, v240, v144
  v_mul_f32 v241, v241, v145
  v_mfma_f32_32x32x16_bf16 v[160:175], v[196:199], v[36:39], v[160:175]
  s_waitcnt lgkmcnt(8)
  ds_read_b64_tr_b16 v[188:189], v9 offset:3072
  ds_read_b64_tr_b16 v[190:191], v9 offset:3584
  v_mul_f32 v242, v242, v146
  v_mul_f32 v243, v243, v147
  v_cvt_pk_bf16_f32 v144, v240, v241
  v_cvt_pk_bf16_f32 v145, v242, v243
  v_mul_f32 v244, s15, v148
  v_mul_f32 v245, s15, v149
  v_mul_f32 v246, s15, v150
  v_mfma_f32_32x32x16_bf16 v[160:175], v[200:203], v[40:43], v[160:175]
  s_waitcnt lgkmcnt(8)
  ds_read_b64_tr_b16 v[192:193], v9 offset:8192
  ds_read_b64_tr_b16 v[194:195], v9 offset:8704
  v_mul_f32 v247, s15, v151
  v_exp_f32 v244, v244
  v_exp_f32 v245, v245
  v_exp_f32 v246, v246
  v_mfma_f32_32x32x16_bf16 v[160:175], v[204:207], v[44:47], v[160:175]
  s_waitcnt lgkmcnt(8)
  ds_read_b64_tr_b16 v[196:197], v9 offset:9216
  ds_read_b64_tr_b16 v[198:199], v9 offset:9728
  v_exp_f32 v247, v247
  v_add_f32 v244, 1.0, v244
  v_add_f32 v245, 1.0, v245
  v_add_f32 v246, 1.0, v246
  v_mfma_f32_32x32x16_bf16 v[160:175], v[176:179], v[48:51], v[160:175]
  s_waitcnt lgkmcnt(8)
  ds_read_b64_tr_b16 v[200:201], v9 offset:10240
  ds_read_b64_tr_b16 v[202:203], v9 offset:10752
  v_add_f32 v247, 1.0, v247
  v_rcp_f32 v244, v244
  v_rcp_f32 v245, v245
  v_rcp_f32 v246, v246
  v_mfma_f32_32x32x16_bf16 v[160:175], v[180:183], v[52:55], v[160:175]
  s_waitcnt lgkmcnt(8)
  ds_read_b64_tr_b16 v[204:205], v9 offset:11264
  ds_read_b64_tr_b16 v[206:207], v9 offset:11776
  v_rcp_f32 v247, v247
  v_mul_f32 v244, v244, v148
  v_mul_f32 v245, v245, v149
  v_mul_f32 v246, v246, v150
  v_mul_f32 v247, v247, v151
  v_mfma_f32_32x32x16_bf16 v[160:175], v[184:187], v[56:59], v[160:175]
  s_waitcnt lgkmcnt(8)
  ds_read_b64_tr_b16 v[176:177], v9 offset:16384
  ds_read_b64_tr_b16 v[178:179], v9 offset:16896
  v_cvt_pk_bf16_f32 v146, v244, v245
  v_cvt_pk_bf16_f32 v147, v246, v247
  buffer_store_dwordx4 v[144:147], v11, s[36:39], s16 offen offset:0 sc1
  v_mul_f32 v240, s15, v152
  v_mul_f32 v241, s15, v153
  v_mul_f32 v242, s15, v154
  v_mul_f32 v243, s15, v155
  v_mfma_f32_32x32x16_bf16 v[160:175], v[188:191], v[60:63], v[160:175]
  s_waitcnt lgkmcnt(8)
  ds_read_b64_tr_b16 v[180:181], v9 offset:17408
  ds_read_b64_tr_b16 v[182:183], v9 offset:17920
  v_exp_f32 v240, v240
  v_exp_f32 v241, v241
  v_exp_f32 v242, v242
  v_mfma_f32_32x32x16_bf16 v[160:175], v[192:195], v[64:67], v[160:175]
  s_waitcnt lgkmcnt(8)
  ds_read_b64_tr_b16 v[184:185], v9 offset:18432
  ds_read_b64_tr_b16 v[186:187], v9 offset:18944
  v_exp_f32 v243, v243
  v_add_f32 v240, 1.0, v240
  v_add_f32 v241, 1.0, v241
  v_add_f32 v242, 1.0, v242
  v_add_f32 v243, 1.0, v243
  v_rcp_f32 v240, v240
  v_mfma_f32_32x32x16_bf16 v[160:175], v[196:199], v[68:71], v[160:175]
  s_waitcnt lgkmcnt(8)
  ds_read_b64_tr_b16 v[188:189], v9 offset:19456
  ds_read_b64_tr_b16 v[190:191], v9 offset:19968
  v_rcp_f32 v241, v241
  v_rcp_f32 v242, v242
  v_rcp_f32 v243, v243
  v_mfma_f32_32x32x16_bf16 v[160:175], v[200:203], v[72:75], v[160:175]
  s_waitcnt lgkmcnt(8)
  ds_read_b64_tr_b16 v[192:193], v9 offset:24576
  ds_read_b64_tr_b16 v[194:195], v9 offset:25088
  v_mul_f32 v240, v240, v152
  v_mul_f32 v241, v241, v153
  v_mul_f32 v242, v242, v154
  v_mul_f32 v243, v243, v155
  v_cvt_pk_bf16_f32 v148, v240, v241
  v_mfma_f32_32x32x16_bf16 v[160:175], v[204:207], v[76:79], v[160:175]
  s_waitcnt lgkmcnt(8)
  ds_read_b64_tr_b16 v[196:197], v9 offset:25600
  ds_read_b64_tr_b16 v[198:199], v9 offset:26112
  v_cvt_pk_bf16_f32 v149, v242, v243
  v_mul_f32 v244, s15, v156
  v_mul_f32 v245, s15, v157
  v_mul_f32 v246, s15, v158
  v_mul_f32 v247, s15, v159
  v_exp_f32 v244, v244
  v_mfma_f32_32x32x16_bf16 v[160:175], v[176:179], v[80:83], v[160:175]
  s_waitcnt vmcnt(1) lgkmcnt(8)
  ds_read_b64_tr_b16 v[200:201], v9 offset:26624
  ds_read_b64_tr_b16 v[202:203], v9 offset:27136
  s_buffer_atomic_swap s68, s[36:39], s44 offset:16
  v_exp_f32 v245, v245
  v_exp_f32 v246, v246
  v_exp_f32 v247, v247
  v_mfma_f32_32x32x16_bf16 v[160:175], v[180:183], v[84:87], v[160:175]
  s_waitcnt lgkmcnt(8)
  ds_read_b64_tr_b16 v[204:205], v9 offset:27648
  ds_read_b64_tr_b16 v[206:207], v9 offset:28160
  v_add_f32 v244, 1.0, v244
  v_add_f32 v245, 1.0, v245
  v_add_f32 v246, 1.0, v246
  v_add_f32 v247, 1.0, v247
  v_rcp_f32 v244, v244
  v_rcp_f32 v245, v245
  v_mfma_f32_32x32x16_bf16 v[160:175], v[184:187], v[88:91], v[160:175]
  s_waitcnt lgkmcnt(8)
  ds_read_b64_tr_b16 v[176:177], v9 offset:32768
  ds_read_b64_tr_b16 v[178:179], v9 offset:33280
  v_rcp_f32 v246, v246
  v_rcp_f32 v247, v247
  v_mul_f32 v244, v244, v156
  s_buffer_load_dwordx4 s[48:51], s[36:39], s7 offset:0 glc
  v_mfma_f32_32x32x16_bf16 v[160:175], v[188:191], v[92:95], v[160:175]
  s_waitcnt lgkmcnt(8)
  ds_read_b64_tr_b16 v[180:181], v9 offset:33792
  ds_read_b64_tr_b16 v[182:183], v9 offset:34304
  v_mul_f32 v245, v245, v157
  v_mul_f32 v246, v246, v158
  v_mul_f32 v247, v247, v159
  v_cvt_pk_bf16_f32 v150, v244, v245
  v_cvt_pk_bf16_f32 v151, v246, v247
  buffer_store_dwordx4 v[148:151], v11, s[36:39], s16 offen offset:1024 sc1
  v_mfma_f32_32x32x16_bf16 v[160:175], v[192:195], v[96:99], v[160:175]
  s_waitcnt lgkmcnt(8)
  ds_read_b64_tr_b16 v[184:185], v9 offset:34816
  ds_read_b64_tr_b16 v[186:187], v9 offset:35328
  v_mfma_f32_32x32x16_bf16 v[160:175], v[196:199], v[100:103], v[160:175]
  s_waitcnt lgkmcnt(8)
  ds_read_b64_tr_b16 v[188:189], v9 offset:35840
  ds_read_b64_tr_b16 v[190:191], v9 offset:36352
  v_mfma_f32_32x32x16_bf16 v[160:175], v[200:203], v[104:107], v[160:175]
  s_waitcnt lgkmcnt(8)
  ds_read_b64_tr_b16 v[192:193], v9 offset:40960
  ds_read_b64_tr_b16 v[194:195], v9 offset:41472
  ds_read_b32 v3, v1 offset:512
  v_mfma_f32_32x32x16_bf16 v[160:175], v[204:207], v[108:111], v[160:175]
  s_waitcnt lgkmcnt(9)
  ds_read_b64_tr_b16 v[196:197], v9 offset:41984
  ds_read_b64_tr_b16 v[198:199], v9 offset:42496
  v_mfma_f32_32x32x16_bf16 v[160:175], v[176:179], v[112:115], v[160:175]
  s_waitcnt lgkmcnt(9)
  ds_read_b64_tr_b16 v[200:201], v9 offset:43008
  ds_read_b64_tr_b16 v[202:203], v9 offset:43520
  v_mfma_f32_32x32x16_bf16 v[160:175], v[180:183], v[116:119], v[160:175]
  s_waitcnt lgkmcnt(4)
  ds_read_b64_tr_b16 v[204:205], v9 offset:44032
  ds_read_b64_tr_b16 v[206:207], v9 offset:44544
  v_cmp_ne_u32 vcc, 0, v3
  v_mfma_f32_32x32x16_bf16 v[160:175], v[184:187], v[120:123], v[160:175]
  s_cbranch_vccnz slow_g512
back_g512:
  ds_read_b64_tr_b16 v[176:177], v4 offset:0
  ds_read_b64_tr_b16 v[178:179], v4 offset:2048
  v_mfma_f32_32x32x16_bf16 v[160:175], v[188:191], v[124:127], v[160:175]
  ds_read_b64_tr_b16 v[180:181], v5 offset:0
  ds_read_b64_tr_b16 v[182:183], v5 offset:2048
  v_mfma_f32_32x32x16_bf16 v[160:175], v[192:195], v[128:131], v[160:175]
  s_waitcnt lgkmcnt(8)
  ds_read_b64_tr_b16 v[184:185], v6 offset:0
  ds_read_b64_tr_b16 v[186:187], v6 offset:2048
  v_mfma_f32_32x32x16_bf16 v[160:175], v[196:199], v[132:135], v[160:175]
  s_waitcnt lgkmcnt(8)
  ds_read_b64_tr_b16 v[188:189], v7 offset:0
  ds_read_b64_tr_b16 v[190:191], v7 offset:2048
  v_mfma_f32_32x32x16_bf16 v[160:175], v[200:203], v[136:139], v[160:175]
  s_waitcnt lgkmcnt(8)
  ds_read_b64_tr_b16 v[192:193], v4 offset:4096
  ds_read_b64_tr_b16 v[194:195], v4 offset:6144
  ds_write_b32 v254, v252
  ds_write_b32 v13, v10 offset:48
  v_mfma_f32_32x32x16_bf16 v[160:175], v[204:207], v[140:143], v[160:175]
  s_waitcnt lgkmcnt(10)
  ds_read_b64_tr_b16 v[196:197], v5 offset:4096
  ds_read_b64_tr_b16 v[198:199], v5 offset:6144
  v_mfma_f32_32x32x16_bf16 v[80:95], v[176:179], v[208:211], 0
  s_waitcnt lgkmcnt(10)
  ds_read_b64_tr_b16 v[200:201], v6 offset:4096
  ds_read_b64_tr_b16 v[202:203], v6 offset:6144
  v_mfma_f32_32x32x16_bf16 v[96:111], v[180:183], v[208:211], 0
  s_waitcnt lgkmcnt(10)
  ds_read_b64_tr_b16 v[204:205], v7 offset:4096
  ds_read_b64_tr_b16 v[206:207], v7 offset:6144
  v_mul_f32 v240, s15, v160
  v_mul_f32 v241, s15, v161
  v_mul_f32 v242, s15, v162
  v_mul_f32 v243, s15, v163
  v_exp_f32 v240, v240
  v_exp_f32 v241, v241
  v_mfma_f32_32x32x16_bf16 v[112:127], v[184:187], v[208:211], 0
  s_waitcnt lgkmcnt(10)
  ds_read_b64_tr_b16 v[176:177], v4 offset:8192
  ds_read_b64_tr_b16 v[178:179], v4 offset:10240
  v_exp_f32 v242, v242
  v_exp_f32 v243, v243
  v_add_f32 v240, 1.0, v240
  v_add_f32 v241, 1.0, v241
  v_add_f32 v242, 1.0, v242
  v_mfma_f32_32x32x16_bf16 v[128:143], v[188:191], v[208:211], 0
  s_waitcnt lgkmcnt(10)
  ds_read_b64_tr_b16 v[180:181], v5 offset:8192
  ds_read_b64_tr_b16 v[182:183], v5 offset:10240
  v_add_f32 v243, 1.0, v243
  v_rcp_f32 v240, v240
  v_rcp_f32 v241, v241
  v_rcp_f32 v242, v242
  v_mfma_f32_32x32x16_bf16 v[80:95], v[192:195], v[212:215], v[80:95]
  s_waitcnt lgkmcnt(8)
  ds_read_b64_tr_b16 v[184:185], v6 offset:8192
  ds_read_b64_tr_b16 v[186:187], v6 offset:10240
  v_rcp_f32 v243, v243
  v_mul_f32 v240, v240, v160
  v_mul_f32 v241, v241, v161
  v_mul_f32 v242, v242, v162
  v_mul_f32 v243, v243, v163
  v_cvt_pk_bf16_f32 v160, v240, v241
  v_mfma_f32_32x32x16_bf16 v[96:111], v[196:199], v[212:215], v[96:111]
  s_waitcnt lgkmcnt(6)
  ds_read_b64_tr_b16 v[188:189], v7 offset:8192
  ds_read_b64_tr_b16 v[190:191], v7 offset:10240
  v_cvt_pk_bf16_f32 v161, v242, v243
  v_mul_f32 v244, s15, v164
  v_mul_f32 v245, s15, v165
  v_mul_f32 v246, s15, v166
  v_mul_f32 v247, s15, v167
  v_exp_f32 v244, v244
  s_xor_b64 s[8:9], s[48:49], s[68:69]
  s_xor_b64 s[10:11], s[50:51], s[68:69]
  s_or_b64 s[8:9], s[8:9], s[10:11]
  v_mfma_f32_32x32x16_bf16 v[112:127], v[200:203], v[212:215], v[112:127]
  s_cbranch_scc1 slow_h0
back_h0:
  s_waitcnt vmcnt(0)
  ds_read_b64_tr_b16 v[192:193], v4 offset:20480
  ds_read_b64_tr_b16 v[194:195], v4 offset:22528
  s_buffer_atomic_swap s68, s[36:39], s44 offset:32
  buffer_load_dwordx4 v[16:19], v2, s[36:39], s17 offen offset:0 sc1
  v_exp_f32 v245, v245
  v_exp_f32 v246, v246
  v_exp_f32 v247, v247
  v_add_f32 v244, 1.0, v244
  v_add_f32 v245, 1.0, v245
  s_buffer_load_dwordx4 s[52:55], s[36:39], s7 offset:16 glc
  v_mfma_f32_32x32x16_bf16 v[128:143], v[204:207], v[212:215], v[128:143]
  s_waitcnt lgkmcnt(8)
  ds_read_b64_tr_b16 v[196:197], v5 offset:20480
  ds_read_b64_tr_b16 v[198:199], v5 offset:22528
  v_add_f32 v246, 1.0, v246
  v_add_f32 v247, 1.0, v247
  v_rcp_f32 v244, v244
  v_rcp_f32 v245, v245
  v_rcp_f32 v246, v246
  v_mfma_f32_32x32x16_bf16 v[80:95], v[176:179], v[224:227], v[80:95]
  s_waitcnt lgkmcnt(8)
  ds_read_b64_tr_b16 v[200:201], v6 offset:20480
  ds_read_b64_tr_b16 v[202:203], v6 offset:22528
  buffer_load_dwordx4 v[20:23], v2, s[36:39], s17 offen offset:1024 sc1
  v_rcp_f32 v247, v247
  v_mul_f32 v244, v244, v164
  v_mul_f32 v245, v245, v165
  v_mul_f32 v246, v246, v166
  v_mul_f32 v247, v247, v167
  v_mfma_f32_32x32x16_bf16 v[96:111], v[180:183], v[224:227], v[96:111]
  s_waitcnt lgkmcnt(8)
  ds_read_b64_tr_b16 v[204:205], v7 offset:20480
  ds_read_b64_tr_b16 v[206:207], v7 offset:22528
  v_cvt_pk_bf16_f32 v162, v244, v245
  v_cvt_pk_bf16_f32 v163, v246, v247
  buffer_store_dwordx4 v[160:163], v251, s[36:39], s16 offen offset:2048 sc1
  v_mul_f32 v240, s15, v168
  v_mul_f32 v241, s15, v169
  v_mul_f32 v242, s15, v170
  v_mul_f32 v243, s15, v171
  v_mfma_f32_32x32x16_bf16 v[112:127], v[184:187], v[224:227], v[112:127]
  s_waitcnt lgkmcnt(8)
  ds_read_b64_tr_b16 v[176:177], v4 offset:24576
  ds_read_b64_tr_b16 v[178:179], v4 offset:26624
  ds_read_b32 v3, v1 offset:528
  buffer_load_dwordx4 v[24:27], v2, s[36:39], s18 offen offset:0 sc1
  v_exp_f32 v240, v240
  v_exp_f32 v241, v241
  v_exp_f32 v242, v242
  v_exp_f32 v243, v243
  v_mfma_f32_32x32x16_bf16 v[128:143], v[188:191], v[224:227], v[128:143]
  s_waitcnt lgkmcnt(9)
  ds_read_b64_tr_b16 v[180:181], v5 offset:24576
  ds_read_b64_tr_b16 v[182:183], v5 offset:26624
  v_add_f32 v240, 1.0, v240
  v_add_f32 v241, 1.0, v241
  v_add_f32 v242, 1.0, v242
  v_add_f32 v243, 1.0, v243
  v_rcp_f32 v240, v240
  v_mfma_f32_32x32x16_bf16 v[80:95], v[192:195], v[228:231], v[80:95]
  s_waitcnt lgkmcnt(9)
  ds_read_b64_tr_b16 v[184:185], v6 offset:24576
  ds_read_b64_tr_b16 v[186:187], v6 offset:26624
  buffer_load_dwordx4 v[28:31], v2, s[36:39], s18 offen offset:1024 sc1
  v_rcp_f32 v241, v241
  v_rcp_f32 v242, v242
  v_rcp_f32 v243, v243
  v_mul_f32 v240, v240, v168
  v_mul_f32 v241, v241, v169
  v_mfma_f32_32x32x16_bf16 v[96:111], v[196:199], v[228:231], v[96:111]
  s_waitcnt lgkmcnt(4)
  ds_read_b64_tr_b16 v[188:189], v7 offset:24576
  ds_read_b64_tr_b16 v[190:191], v7 offset:26624
  v_cmp_ne_u32 vcc, 0, v3
  v_mul_f32 v242, v242, v170
  v_mul_f32 v243, v243, v171
  v_cvt_pk_bf16_f32 v164, v240, v241
  v_cvt_pk_bf16_f32 v165, v242, v243
  v_mul_f32 v244, s15, v172
  v_mul_f32 v245, s15, v173
  v_mul_f32 v246, s15, v174
  v_subrev_u32 v4, 131072, v4
  v_mfma_f32_32x32x16_bf16 v[112:127], v[200:203], v[228:231], v[112:127]
  s_cbranch_vccnz slow_g528
back_g528:
  ds_read_b64_tr_b16 v[192:193], v4 offset:0
  ds_read_b64_tr_b16 v[194:195], v4 offset:2048
  buffer_load_dwordx4 v[32:35], v2, s[36:39], s19 offen offset:0 sc1
  v_mul_f32 v247, s15, v175
  v_exp_f32 v244, v244
  v_exp_f32 v245, v245
  v_exp_f32 v246, v246
  v_subrev_u32 v5, 131072, v5
  v_mfma_f32_32x32x16_bf16 v[128:143], v[204:207], v[228:231], v[128:143]
  ds_read_b64_tr_b16 v[196:197], v5 offset:0
  ds_read_b64_tr_b16 v[198:199], v5 offset:2048
  v_exp_f32 v247, v247
  v_add_f32 v244, 1.0, v244
  v_add_f32 v245, 1.0, v245
  v_add_f32 v246, 1.0, v246
  v_add_f32 v247, 1.0, v247
  v_rcp_f32 v244, v244
  v_subrev_u32 v6, 131072, v6
  v_mfma_f32_32x32x16_bf16 v[80:95], v[176:179], v[144:147], v[80:95]
  s_waitcnt lgkmcnt(8)
  ds_read_b64_tr_b16 v[200:201], v6 offset:0
  ds_read_b64_tr_b16 v[202:203], v6 offset:2048
  buffer_load_dwordx4 v[36:39], v2, s[36:39], s19 offen offset:1024 sc1
  v_rcp_f32 v245, v245
  v_rcp_f32 v246, v246
  v_rcp_f32 v247, v247
  v_subrev_u32 v7, 131072, v7
  v_mfma_f32_32x32x16_bf16 v[96:111], v[180:183], v[144:147], v[96:111]
  s_waitcnt lgkmcnt(8)
  ds_read_b64_tr_b16 v[204:205], v7 offset:0
  ds_read_b64_tr_b16 v[206:207], v7 offset:2048
  v_mul_f32 v244, v244, v172
  v_mul_f32 v245, v245, v173
  v_mul_f32 v246, v246, v174
  v_mul_f32 v247, v247, v175
  v_cvt_pk_bf16_f32 v166, v244, v245
  v_cvt_pk_bf16_f32 v167, v246, v247
  buffer_store_dwordx4 v[164:167], v251, s[36:39], s16 offen offset:3072 sc1
  v_mfma_f32_32x32x16_bf16 v[112:127], v[184:187], v[144:147], v[112:127]
  s_waitcnt lgkmcnt(8)
  ds_read_b64_tr_b16 v[176:177], v4 offset:4096
  ds_read_b64_tr_b16 v[178:179], v4 offset:6144
  v_mfma_f32_32x32x16_bf16 v[128:143], v[188:191], v[144:147], v[128:143]
  s_waitcnt lgkmcnt(8)
  ds_read_b64_tr_b16 v[180:181], v5 offset:4096
  ds_read_b64_tr_b16 v[182:183], v5 offset:6144
  v_mfma_f32_32x32x16_bf16 v[80:95], v[192:195], v[148:151], v[80:95]
  s_waitcnt lgkmcnt(8)
  ds_read_b64_tr_b16 v[184:185], v6 offset:4096
  ds_read_b64_tr_b16 v[186:187], v6 offset:6144
  v_mfma_f32_32x32x16_bf16 v[96:111], v[196:199], v[148:151], v[96:111]
  s_waitcnt lgkmcnt(8)
  ds_read_b64_tr_b16 v[188:189], v7 offset:4096
  ds_read_b64_tr_b16 v[190:191], v7 offset:6144
  v_mfma_f32_32x32x16_bf16 v[112:127], v[200:203], v[148:151], v[112:127]
  s_waitcnt lgkmcnt(8)
  ds_read_b64_tr_b16 v[192:193], v4 offset:8192
  ds_read_b64_tr_b16 v[194:195], v4 offset:10240
  v_mfma_f32_32x32x16_bf16 v[128:143], v[204:207], v[148:151], v[128:143]
  s_waitcnt vmcnt(7) lgkmcnt(8)
  ds_read_b64_tr_b16 v[196:197], v5 offset:8192
  ds_read_b64_tr_b16 v[198:199], v5 offset:10240
  v_mfma_f32_32x32x16_bf16 v[80:95], v[176:179], v[16:19], v[80:95]
  s_waitcnt lgkmcnt(8)
  ds_read_b64_tr_b16 v[200:201], v6 offset:8192
  ds_read_b64_tr_b16 v[202:203], v6 offset:10240
  v_mfma_f32_32x32x16_bf16 v[96:111], v[180:183], v[16:19], v[96:111]
  s_waitcnt lgkmcnt(6)
  ds_read_b64_tr_b16 v[204:205], v7 offset:8192
  ds_read_b64_tr_b16 v[206:207], v7 offset:10240
  s_xor_b64 s[8:9], s[52:53], s[68:69]
  s_xor_b64 s[10:11], s[54:55], s[68:69]
  s_or_b64 s[8:9], s[8:9], s[10:11]
  v_mfma_f32_32x32x16_bf16 v[112:127], v[184:187], v[16:19], v[112:127]
  s_cbranch_scc1 slow_h1
back_h1:
  ds_read_b64_tr_b16 v[176:177], v4 offset:12288
  ds_read_b64_tr_b16 v[178:179], v4 offset:14336
  ds_read_b32 v3, v1 offset:544
  buffer_load_dwordx4 v[40:43], v2, s[36:39], s17 offen offset:2048 sc1
  v_mfma_f32_32x32x16_bf16 v[128:143], v[188:191], v[16:19], v[128:143]
  s_waitcnt vmcnt(7) lgkmcnt(9)
  ds_read_b64_tr_b16 v[180:181], v5 offset:12288
  ds_read_b64_tr_b16 v[182:183], v5 offset:14336
  v_mfma_f32_32x32x16_bf16 v[80:95], v[192:195], v[20:23], v[80:95]
  s_waitcnt lgkmcnt(9)
  ds_read_b64_tr_b16 v[184:185], v6 offset:12288
  ds_read_b64_tr_b16 v[186:187], v6 offset:14336
  buffer_load_dwordx4 v[44:47], v2, s[36:39], s17 offen offset:3072 sc1
  v_mfma_f32_32x32x16_bf16 v[96:111], v[196:199], v[20:23], v[96:111]
  s_waitcnt lgkmcnt(4)
  ds_read_b64_tr_b16 v[188:189], v7 offset:12288
  ds_read_b64_tr_b16 v[190:191], v7 offset:14336
  v_cmp_ne_u32 vcc, 0, v3
  v_mfma_f32_32x32x16_bf16 v[112:127], v[200:203], v[20:23], v[112:127]
  s_cbranch_vccnz slow_g544
back_g544:
  ds_read_b64_tr_b16 v[192:193], v4 offset:16384
  ds_read_b64_tr_b16 v[194:195], v4 offset:18432
  buffer_load_dwordx4 v[48:51], v2, s[36:39], s18 offen offset:2048 sc1
  s_buffer_load_dwordx4 s[56:59], s[36:39], s7 offset:32 glc
  v_mov_b32 v10, 3
  ds_write_b32 v13, v10 offset:48
  v_mfma_f32_32x32x16_bf16 v[128:143], v[204:207], v[20:23], v[128:143]
  s_waitcnt vmcnt(7)
  ds_read_b64_tr_b16 v[196:197], v5 offset:16384
  ds_read_b64_tr_b16 v[198:199], v5 offset:18432
  v_mfma_f32_32x32x16_bf16 v[80:95], v[176:179], v[24:27], v[80:95]
  s_waitcnt lgkmcnt(9)
  ds_read_b64_tr_b16 v[200:201], v6 offset:16384
  ds_read_b64_tr_b16 v[202:203], v6 offset:18432
  buffer_load_dwordx4 v[52:55], v2, s[36:39], s18 offen offset:3072 sc1
  v_mfma_f32_32x32x16_bf16 v[96:111], v[180:183], v[24:27], v[96:111]
  s_waitcnt lgkmcnt(9)
  ds_read_b64_tr_b16 v[204:205], v7 offset:16384
  ds_read_b64_tr_b16 v[206:207], v7 offset:18432
  v_mfma_f32_32x32x16_bf16 v[112:127], v[184:187], v[24:27], v[112:127]
  s_waitcnt lgkmcnt(9)
  ds_read_b64_tr_b16 v[176:177], v4 offset:20480
  ds_read_b64_tr_b16 v[178:179], v4 offset:22528
  buffer_load_dwordx4 v[56:59], v2, s[36:39], s19 offen offset:2048 sc1
  v_mfma_f32_32x32x16_bf16 v[128:143], v[188:191], v[24:27], v[128:143]
  s_waitcnt vmcnt(8) lgkmcnt(9)
  ds_read_b64_tr_b16 v[180:181], v5 offset:20480
  ds_read_b64_tr_b16 v[182:183], v5 offset:22528
  v_mfma_f32_32x32x16_bf16 v[80:95], v[192:195], v[28:31], v[80:95]
  s_waitcnt vmcnt(5) lgkmcnt(8)
  ds_read_b64_tr_b16 v[184:185], v6 offset:20480
  ds_read_b64_tr_b16 v[186:187], v6 offset:22528
  s_buffer_atomic_swap s68, s[36:39], s44 offset:48
  buffer_load_dwordx4 v[60:63], v2, s[36:39], s19 offen offset:3072 sc1
  v_mfma_f32_32x32x16_bf16 v[96:111], v[196:199], v[28:31], v[96:111]
  s_waitcnt lgkmcnt(8)
  ds_read_b64_tr_b16 v[188:189], v7 offset:20480
  ds_read_b64_tr_b16 v[190:191], v7 offset:22528
  v_mfma_f32_32x32x16_bf16 v[112:127], v[200:203], v[28:31], v[112:127]
  s_waitcnt lgkmcnt(8)
  ds_read_b64_tr_b16 v[192:193], v4 offset:24576
  ds_read_b64_tr_b16 v[194:195], v4 offset:26624
  v_mfma_f32_32x32x16_bf16 v[128:143], v[204:207], v[28:31], v[128:143]
  s_waitcnt lgkmcnt(8)
  ds_read_b64_tr_b16 v[196:197], v5 offset:24576
  ds_read_b64_tr_b16 v[198:199], v5 offset:26624
  v_mfma_f32_32x32x16_bf16 v[80:95], v[176:179], v[32:35], v[80:95]
  s_waitcnt lgkmcnt(8)
  ds_read_b64_tr_b16 v[200:201], v6 offset:24576
  ds_read_b64_tr_b16 v[202:203], v6 offset:26624
  v_mfma_f32_32x32x16_bf16 v[96:111], v[180:183], v[32:35], v[96:111]
  s_waitcnt lgkmcnt(8)
  ds_read_b64_tr_b16 v[204:205], v7 offset:24576
  ds_read_b64_tr_b16 v[206:207], v7 offset:26624
  v_mfma_f32_32x32x16_bf16 v[112:127], v[184:187], v[32:35], v[112:127]
  s_waitcnt lgkmcnt(8)
  ds_read_b64_tr_b16 v[176:177], v4 offset:28672
  ds_read_b64_tr_b16 v[178:179], v4 offset:30720
  ds_read_b32 v3, v1 offset:560
  v_mfma_f32_32x32x16_bf16 v[128:143], v[188:191], v[32:35], v[128:143]
  s_waitcnt lgkmcnt(9)
  ds_read_b64_tr_b16 v[180:181], v5 offset:28672
  ds_read_b64_tr_b16 v[182:183], v5 offset:30720
  v_mfma_f32_32x32x16_bf16 v[80:95], v[192:195], v[36:39], v[80:95]
  s_waitcnt lgkmcnt(9)
  ds_read_b64_tr_b16 v[184:185], v6 offset:28672
  ds_read_b64_tr_b16 v[186:187], v6 offset:30720
  v_mfma_f32_32x32x16_bf16 v[96:111], v[196:199], v[36:39], v[96:111]
  s_waitcnt lgkmcnt(4)
  ds_read_b64_tr_b16 v[188:189], v7 offset:28672
  ds_read_b64_tr_b16 v[190:191], v7 offset:30720
  v_cmp_ne_u32 vcc, 0, v3
  v_mfma_f32_32x32x16_bf16 v[112:127], v[200:203], v[36:39], v[112:127]
  s_cbranch_vccnz slow_g560
back_g560:
  ds_read_b64_tr_b16 v[192:193], v4 offset:32768
  ds_read_b64_tr_b16 v[194:195], v4 offset:34816
  v_mfma_f32_32x32x16_bf16 v[128:143], v[204:207], v[36:39], v[128:143]
  s_waitcnt vmcnt(5)
  ds_read_b64_tr_b16 v[196:197], v5 offset:32768
  ds_read_b64_tr_b16 v[198:199], v5 offset:34816
  v_mfma_f32_32x32x16_bf16 v[80:95], v[176:179], v[40:43], v[80:95]
  s_waitcnt lgkmcnt(8)
  ds_read_b64_tr_b16 v[200:201], v6 offset:32768
  ds_read_b64_tr_b16 v[202:203], v6 offset:34816
  v_mfma_f32_32x32x16_bf16 v[96:111], v[180:183], v[40:43], v[96:111]
  s_waitcnt lgkmcnt(6)
  ds_read_b64_tr_b16 v[204:205], v7 offset:32768
  ds_read_b64_tr_b16 v[206:207], v7 offset:34816
  s_xor_b64 s[8:9], s[56:57], s[68:69]
  s_xor_b64 s[10:11], s[58:59], s[68:69]
  s_or_b64 s[8:9], s[8:9], s[10:11]
  v_mfma_f32_32x32x16_bf16 v[112:127], v[184:187], v[40:43], v[112:127]
  s_cbranch_scc1 slow_h2
back_h2:
  ds_read_b64_tr_b16 v[176:177], v4 offset:36864
  ds_read_b64_tr_b16 v[178:179], v4 offset:38912
  buffer_load_dwordx4 v[64:67], v11, s[36:39], s17 offen offset:0 sc1
  v_mfma_f32_32x32x16_bf16 v[128:143], v[188:191], v[40:43], v[128:143]
  s_waitcnt vmcnt(5) lgkmcnt(8)
  ds_read_b64_tr_b16 v[180:181], v5 offset:36864
  ds_read_b64_tr_b16 v[182:183], v5 offset:38912
  v_mfma_f32_32x32x16_bf16 v[80:95], v[192:195], v[44:47], v[80:95]
  s_waitcnt lgkmcnt(8)
  ds_read_b64_tr_b16 v[184:185], v6 offset:36864
  ds_read_b64_tr_b16 v[186:187], v6 offset:38912
  buffer_load_dwordx4 v[68:71], v11, s[36:39], s17 offen offset:1024 sc1
  v_mfma_f32_32x32x16_bf16 v[96:111], v[196:199], v[44:47], v[96:111]
  s_waitcnt lgkmcnt(8)
  ds_read_b64_tr_b16 v[188:189], v7 offset:36864
  ds_read_b64_tr_b16 v[190:191], v7 offset:38912
  v_mfma_f32_32x32x16_bf16 v[112:127], v[200:203], v[44:47], v[112:127]
  s_waitcnt lgkmcnt(8)
  ds_read_b64_tr_b16 v[192:193], v4 offset:40960
  ds_read_b64_tr_b16 v[194:195], v4 offset:43008
  buffer_load_dwordx4 v[72:75], v11, s[36:39], s18 offen offset:0 sc1
  v_mfma_f32_32x32x16_bf16 v[128:143], v[204:207], v[44:47], v[128:143]
  s_waitcnt vmcnt(6) lgkmcnt(8)
  ds_read_b64_tr_b16 v[196:197], v5 offset:40960
  ds_read_b64_tr_b16 v[198:199], v5 offset:43008
  v_mfma_f32_32x32x16_bf16 v[80:95], v[176:179], v[48:51], v[80:95]
  s_waitcnt lgkmcnt(8)
  ds_read_b64_tr_b16 v[200:201], v6 offset:40960
  ds_read_b64_tr_b16 v[202:203], v6 offset:43008
  buffer_load_dwordx4 v[76:79], v11, s[36:39], s18 offen offset:1024 sc1
  s_buffer_load_dwordx4 s[32:35], s[36:39], s7 offset:48 glc
  v_mfma_f32_32x32x16_bf16 v[96:111], v[180:183], v[48:51], v[96:111]
  s_waitcnt lgkmcnt(8)
  ds_read_b64_tr_b16 v[204:205], v7 offset:40960
  ds_read_b64_tr_b16 v[206:207], v7 offset:43008
  v_mfma_f32_32x32x16_bf16 v[112:127], v[184:187], v[48:51], v[112:127]
  s_waitcnt lgkmcnt(8)
  ds_read_b64_tr_b16 v[176:177], v4 offset:45056
  ds_read_b64_tr_b16 v[178:179], v4 offset:47104
  ds_read_b32 v3, v1 offset:576
  buffer_load_dwordx4 v[216:219], v11, s[36:39], s19 offen offset:0 sc1
  v_mfma_f32_32x32x16_bf16 v[128:143], v[188:191], v[48:51], v[128:143]
  s_waitcnt vmcnt(7) lgkmcnt(9)
  ds_read_b64_tr_b16 v[180:181], v5 offset:45056
  ds_read_b64_tr_b16 v[182:183], v5 offset:47104
  v_mfma_f32_32x32x16_bf16 v[80:95], v[192:195], v[52:55], v[80:95]
  s_waitcnt lgkmcnt(9)
  ds_read_b64_tr_b16 v[184:185], v6 offset:45056
  ds_read_b64_tr_b16 v[186:187], v6 offset:47104
  buffer_load_dwordx4 v[220:223], v11, s[36:39], s19 offen offset:1024 sc1
  v_mfma_f32_32x32x16_bf16 v[96:111], v[196:199], v[52:55], v[96:111]
  s_waitcnt lgkmcnt(4)
  ds_read_b64_tr_b16 v[188:189], v7 offset:45056
  ds_read_b64_tr_b16 v[190:191], v7 offset:47104
  v_cmp_ne_u32 vcc, 0, v3
  v_mfma_f32_32x32x16_bf16 v[112:127], v[200:203], v[52:55], v[112:127]
  s_cbranch_vccnz slow_g576
back_g576:
  ds_read_b64_tr_b16 v[192:193], v4 offset:49152
  ds_read_b64_tr_b16 v[194:195], v4 offset:51200
  v_mfma_f32_32x32x16_bf16 v[128:143], v[204:207], v[52:55], v[128:143]
  s_waitcnt vmcnt(7)
  ds_read_b64_tr_b16 v[196:197], v5 offset:49152
  ds_read_b64_tr_b16 v[198:199], v5 offset:51200
  v_mfma_f32_32x32x16_bf16 v[80:95], v[176:179], v[56:59], v[80:95]
  s_waitcnt lgkmcnt(8)
  ds_read_b64_tr_b16 v[200:201], v6 offset:49152
  ds_read_b64_tr_b16 v[202:203], v6 offset:51200
  v_mfma_f32_32x32x16_bf16 v[96:111], v[180:183], v[56:59], v[96:111]
  s_waitcnt lgkmcnt(8)
  ds_read_b64_tr_b16 v[204:205], v7 offset:49152
  ds_read_b64_tr_b16 v[206:207], v7 offset:51200
  v_mfma_f32_32x32x16_bf16 v[112:127], v[184:187], v[56:59], v[112:127]
  s_waitcnt lgkmcnt(8)
  ds_read_b64_tr_b16 v[176:177], v4 offset:53248
  ds_read_b64_tr_b16 v[178:179], v4 offset:55296
  ds_read_b32 v3, v1 offset:48
  v_mfma_f32_32x32x16_bf16 v[128:143], v[188:191], v[56:59], v[128:143]
  s_waitcnt vmcnt(6) lgkmcnt(9)
  ds_read_b64_tr_b16 v[180:181], v5 offset:53248
  ds_read_b64_tr_b16 v[182:183], v5 offset:55296
  v_mfma_f32_32x32x16_bf16 v[80:95], v[192:195], v[60:63], v[80:95]
  s_waitcnt lgkmcnt(9)
  ds_read_b64_tr_b16 v[184:185], v6 offset:53248
  ds_read_b64_tr_b16 v[186:187], v6 offset:55296
  v_mfma_f32_32x32x16_bf16 v[96:111], v[196:199], v[60:63], v[96:111]
  s_waitcnt lgkmcnt(4)
  ds_read_b64_tr_b16 v[188:189], v7 offset:53248
  ds_read_b64_tr_b16 v[190:191], v7 offset:55296
  v_cmp_gt_u32 vcc, 3, v3
  v_mfma_f32_32x32x16_bf16 v[112:127], v[200:203], v[60:63], v[112:127]
  s_cbranch_vccnz slow_g48
back_g48:
  ds_read_b64_tr_b16 v[192:193], v4 offset:57344
  ds_read_b64_tr_b16 v[194:195], v4 offset:59392
  v_mfma_f32_32x32x16_bf16 v[128:143], v[204:207], v[60:63], v[128:143]
  s_waitcnt vmcnt(5)
  ds_read_b64_tr_b16 v[196:197], v5 offset:57344
  ds_read_b64_tr_b16 v[198:199], v5 offset:59392
  v_mfma_f32_32x32x16_bf16 v[80:95], v[176:179], v[64:67], v[80:95]
  s_waitcnt lgkmcnt(8)
  ds_read_b64_tr_b16 v[200:201], v6 offset:57344
  ds_read_b64_tr_b16 v[202:203], v6 offset:59392
  v_mfma_f32_32x32x16_bf16 v[96:111], v[180:183], v[64:67], v[96:111]
  s_waitcnt lgkmcnt(8)
  ds_read_b64_tr_b16 v[204:205], v7 offset:57344
  ds_read_b64_tr_b16 v[206:207], v7 offset:59392
  v_mfma_f32_32x32x16_bf16 v[112:127], v[184:187], v[64:67], v[112:127]
  s_waitcnt lgkmcnt(8)
  ds_read_b64_tr_b16 v[176:177], v4 offset:61440
  ds_read_b64_tr_b16 v[178:179], v4 offset:63488
  ds_read_b32 v3, v1 offset:592
  v_mfma_f32_32x32x16_bf16 v[128:143], v[188:191], v[64:67], v[128:143]
  s_waitcnt vmcnt(4) lgkmcnt(7)
  ds_read_b64_tr_b16 v[180:181], v5 offset:61440
  ds_read_b64_tr_b16 v[182:183], v5 offset:63488
  s_xor_b64 s[8:9], s[32:33], s[68:69]
  s_xor_b64 s[10:11], s[34:35], s[68:69]
  s_or_b64 s[8:9], s[8:9], s[10:11]
  v_mfma_f32_32x32x16_bf16 v[80:95], v[192:195], v[68:71], v[80:95]
  s_cbranch_scc1 slow_h3
back_h3:
  ds_read_b64_tr_b16 v[184:185], v6 offset:61440
  ds_read_b64_tr_b16 v[186:187], v6 offset:63488
  buffer_load_dwordx4 v[232:235], v11, s[36:39], s20 offen offset:2048 sc1
  v_add_u32 v254, s45, v2
  v_mfma_f32_32x32x16_bf16 v[96:111], v[196:199], v[68:71], v[96:111]
  s_waitcnt lgkmcnt(4)
  ds_read_b64_tr_b16 v[188:189], v7 offset:61440
  ds_read_b64_tr_b16 v[190:191], v7 offset:63488
  v_cmp_ne_u32 vcc, 0, v3
  v_add_u32 v4, 0x10000, v4
  v_mfma_f32_32x32x16_bf16 v[112:127], v[200:203], v[68:71], v[112:127]
  s_cbranch_vccnz slow_g592
back_g592:
  ds_read_b64_tr_b16 v[192:193], v4 offset:0
  ds_read_b64_tr_b16 v[194:195], v4 offset:2048
  buffer_load_dwordx4 v[236:239], v11, s[36:39], s20 offen offset:3072 sc1
  v_add_u32 v5, 0x10000, v5
  v_mfma_f32_32x32x16_bf16 v[128:143], v[204:207], v[68:71], v[128:143]
  s_waitcnt vmcnt(5)
  ds_read_b64_tr_b16 v[196:197], v5 offset:0
  ds_read_b64_tr_b16 v[198:199], v5 offset:2048
  v_add_u32 v6, 0x10000, v6
  v_mfma_f32_32x32x16_bf16 v[80:95], v[176:179], v[72:75], v[80:95]
  s_waitcnt lgkmcnt(8)
  ds_read_b64_tr_b16 v[200:201], v6 offset:0
  ds_read_b64_tr_b16 v[202:203], v6 offset:2048
  buffer_load_dwordx4 v[152:155], v11, s[36:39], s21 offen offset:2048 sc1
  v_add_u32 v7, 0x10000, v7
  v_mfma_f32_32x32x16_bf16 v[96:111], v[180:183], v[72:75], v[96:111]
  s_waitcnt lgkmcnt(8)
  ds_read_b64_tr_b16 v[204:205], v7 offset:0
  ds_read_b64_tr_b16 v[206:207], v7 offset:2048
  v_mfma_f32_32x32x16_bf16 v[112:127], v[184:187], v[72:75], v[112:127]
  s_waitcnt lgkmcnt(8)
  ds_read_b64_tr_b16 v[176:177], v4 offset:4096
  ds_read_b64_tr_b16 v[178:179], v4 offset:6144
  buffer_load_dwordx4 v[156:159], v11, s[36:39], s21 offen offset:3072 sc1
  v_mfma_f32_32x32x16_bf16 v[128:143], v[188:191], v[72:75], v[128:143]
  s_waitcnt vmcnt(6) lgkmcnt(8)
  ds_read_b64_tr_b16 v[180:181], v5 offset:4096
  ds_read_b64_tr_b16 v[182:183], v5 offset:6144
  v_mfma_f32_32x32x16_bf16 v[80:95], v[192:195], v[76:79], v[80:95]
  s_waitcnt lgkmcnt(8)
  ds_read_b64_tr_b16 v[184:185], v6 offset:4096
  ds_read_b64_tr_b16 v[186:187], v6 offset:6144
  v_mfma_f32_32x32x16_bf16 v[96:111], v[196:199], v[76:79], v[96:111]
  s_waitcnt lgkmcnt(8)
  ds_read_b64_tr_b16 v[188:189], v7 offset:4096
  ds_read_b64_tr_b16 v[190:191], v7 offset:6144
  v_mfma_f32_32x32x16_bf16 v[112:127], v[200:203], v[76:79], v[112:127]
  s_waitcnt lgkmcnt(8)
  ds_read_b64_tr_b16 v[192:193], v4 offset:8192
  ds_read_b64_tr_b16 v[194:195], v4 offset:10240
  v_mfma_f32_32x32x16_bf16 v[128:143], v[204:207], v[76:79], v[128:143]
  s_waitcnt vmcnt(5) lgkmcnt(8)
  ds_read_b64_tr_b16 v[196:197], v5 offset:8192
  ds_read_b64_tr_b16 v[198:199], v5 offset:10240
  ds_read_b32 v3, v1 offset:608
  v_mfma_f32_32x32x16_bf16 v[80:95], v[176:179], v[216:219], v[80:95]
  s_waitcnt lgkmcnt(9)
  ds_read_b64_tr_b16 v[200:201], v6 offset:8192
  ds_read_b64_tr_b16 v[202:203], v6 offset:10240
  v_mfma_f32_32x32x16_bf16 v[96:111], v[180:183], v[216:219], v[96:111]
  s_waitcnt lgkmcnt(9)
  ds_read_b64_tr_b16 v[204:205], v7 offset:8192
  ds_read_b64_tr_b16 v[206:207], v7 offset:10240
  v_mfma_f32_32x32x16_bf16 v[112:127], v[184:187], v[216:219], v[112:127]
  s_waitcnt lgkmcnt(4)
  ds_read_b64_tr_b16 v[176:177], v4 offset:12288
  ds_read_b64_tr_b16 v[178:179], v4 offset:14336
  v_cmp_ne_u32 vcc, 0, v3
  v_mfma_f32_32x32x16_bf16 v[128:143], v[188:191], v[216:219], v[128:143]
  s_cbranch_vccnz slow_g608
back_g608:
  s_waitcnt vmcnt(4)
  ds_read_b64_tr_b16 v[180:181], v4 offset:16384
  ds_read_b64_tr_b16 v[182:183], v4 offset:18432
  v_mfma_f32_32x32x16_bf16 v[80:95], v[192:195], v[220:223], v[80:95]
  ds_read_b64_tr_b16 v[184:185], v4 offset:20480
  ds_read_b64_tr_b16 v[186:187], v4 offset:22528
  v_mfma_f32_32x32x16_bf16 v[96:111], v[196:199], v[220:223], v[96:111]
  s_waitcnt lgkmcnt(8)
  ds_read_b64_tr_b16 v[188:189], v4 offset:24576
  ds_read_b64_tr_b16 v[190:191], v4 offset:26624
  v_mfma_f32_32x32x16_bf16 v[112:127], v[200:203], v[220:223], v[112:127]
  s_waitcnt lgkmcnt(8)
  ds_read_b64_tr_b16 v[192:193], v5 offset:12288
  ds_read_b64_tr_b16 v[194:195], v5 offset:14336
  v_mfma_f32_32x32x16_bf16 v[128:143], v[204:207], v[220:223], v[128:143]
  s_waitcnt vmcnt(3) lgkmcnt(8)
  ds_read_b64_tr_b16 v[196:197], v5 offset:16384
  ds_read_b64_tr_b16 v[198:199], v5 offset:18432
  v_mfma_f32_32x32x16_bf16 v[80:95], v[176:179], v[232:235], v[80:95]
  s_waitcnt vmcnt(2) lgkmcnt(8)
  ds_read_b64_tr_b16 v[200:201], v5 offset:20480
  ds_read_b64_tr_b16 v[202:203], v5 offset:22528
  v_mfma_f32_32x32x16_bf16 v[80:95], v[180:183], v[236:239], v[80:95]
  s_waitcnt vmcnt(1) lgkmcnt(8)
  ds_read_b64_tr_b16 v[204:205], v5 offset:24576
  ds_read_b64_tr_b16 v[206:207], v5 offset:26624
  v_mfma_f32_32x32x16_bf16 v[80:95], v[184:187], v[152:155], v[80:95]
  s_waitcnt vmcnt(0) lgkmcnt(8)
  ds_read_b64_tr_b16 v[176:177], v6 offset:12288
  ds_read_b64_tr_b16 v[178:179], v6 offset:14336
  v_mfma_f32_32x32x16_bf16 v[80:95], v[188:191], v[156:159], v[80:95]
  s_waitcnt lgkmcnt(8)
  ds_read_b64_tr_b16 v[180:181], v6 offset:16384
  ds_read_b64_tr_b16 v[182:183], v6 offset:18432
  v_mfma_f32_32x32x16_bf16 v[96:111], v[192:195], v[232:235], v[96:111]
  s_waitcnt lgkmcnt(8)
  ds_read_b64_tr_b16 v[184:185], v6 offset:20480
  ds_read_b64_tr_b16 v[186:187], v6 offset:22528
  v_mfma_f32_32x32x16_bf16 v[96:111], v[196:199], v[236:239], v[96:111]
  s_bitcmp1_b32 s45, 18
  s_cbranch_scc0 L_t3
  s_waitcnt lgkmcnt(8)
  ds_read_b64_tr_b16 v[188:189], v6 offset:24576
  ds_read_b64_tr_b16 v[190:191], v6 offset:26624
  v_cvt_pk_bf16_f32 v80, v80, v81
  v_cvt_pk_bf16_f32 v81, v82, v83
  v_cvt_pk_bf16_f32 v82, v84, v85
  v_cvt_pk_bf16_f32 v83, v86, v87
  buffer_store_dwordx4 v[80:83], v2, s[36:39], s22 offen offset:0 sc1
  v_mfma_f32_32x32x16_bf16 v[96:111], v[200:203], v[152:155], v[96:111]
  s_waitcnt lgkmcnt(8)
  ds_read_b64_tr_b16 v[192:193], v7 offset:12288
  ds_read_b64_tr_b16 v[194:195], v7 offset:14336
  v_cvt_pk_bf16_f32 v84, v88, v89
  v_cvt_pk_bf16_f32 v85, v90, v91
  v_cvt_pk_bf16_f32 v86, v92, v93
  v_cvt_pk_bf16_f32 v87, v94, v95
  buffer_store_dwordx4 v[84:87], v2, s[36:39], s22 offen offset:1024 sc1
  v_mfma_f32_32x32x16_bf16 v[96:111], v[204:207], v[156:159], v[96:111]
  s_waitcnt lgkmcnt(8)
  ds_read_b64_tr_b16 v[196:197], v7 offset:16384
  ds_read_b64_tr_b16 v[198:199], v7 offset:18432
  v_mfma_f32_32x32x16_bf16 v[112:127], v[176:179], v[232:235], v[112:127]
  s_waitcnt lgkmcnt(8)
  ds_read_b64_tr_b16 v[200:201], v7 offset:20480
  ds_read_b64_tr_b16 v[202:203], v7 offset:22528
  v_mfma_f32_32x32x16_bf16 v[112:127], v[180:183], v[236:239], v[112:127]
  s_waitcnt lgkmcnt(8)
  ds_read_b64_tr_b16 v[204:205], v7 offset:24576
  ds_read_b64_tr_b16 v[206:207], v7 offset:26624
  v_cvt_pk_bf16_f32 v96, v96, v97
  v_cvt_pk_bf16_f32 v97, v98, v99
  v_cvt_pk_bf16_f32 v98, v100, v101
  v_cvt_pk_bf16_f32 v99, v102, v103
  buffer_store_dwordx4 v[96:99], v2, s[36:39], s22 offen offset:2048 sc1
  v_mfma_f32_32x32x16_bf16 v[112:127], v[184:187], v[152:155], v[112:127]
  s_waitcnt lgkmcnt(8)
  v_cvt_pk_bf16_f32 v100, v104, v105
  v_cvt_pk_bf16_f32 v101, v106, v107
  v_cvt_pk_bf16_f32 v102, v108, v109
  v_cvt_pk_bf16_f32 v103, v110, v111
  buffer_store_dwordx4 v[100:103], v2, s[36:39], s22 offen offset:3072 sc1
  v_mfma_f32_32x32x16_bf16 v[112:127], v[188:191], v[156:159], v[112:127]
  s_waitcnt lgkmcnt(6)
  v_mfma_f32_32x32x16_bf16 v[128:143], v[192:195], v[232:235], v[128:143]
  s_waitcnt lgkmcnt(4)
  v_mfma_f32_32x32x16_bf16 v[128:143], v[196:199], v[236:239], v[128:143]
  s_waitcnt lgkmcnt(2)
  v_cvt_pk_bf16_f32 v112, v112, v113
  v_cvt_pk_bf16_f32 v113, v114, v115
  v_cvt_pk_bf16_f32 v114, v116, v117
  v_cvt_pk_bf16_f32 v115, v118, v119
  buffer_store_dwordx4 v[112:115], v11, s[36:39], s22 offen offset:0 sc1
  v_mfma_f32_32x32x16_bf16 v[128:143], v[200:203], v[152:155], v[128:143]
  s_waitcnt lgkmcnt(0)
  v_cvt_pk_bf16_f32 v116, v120, v121
  v_cvt_pk_bf16_f32 v117, v122, v123
  v_cvt_pk_bf16_f32 v118, v124, v125
  v_cvt_pk_bf16_f32 v119, v126, v127
  buffer_store_dwordx4 v[116:119], v11, s[36:39], s22 offen offset:1024 sc1
  v_mfma_f32_32x32x16_bf16 v[128:143], v[204:207], v[156:159], v[128:143]
s_nop 11
  v_cvt_pk_bf16_f32 v128, v128, v129
  v_cvt_pk_bf16_f32 v129, v130, v131
  v_cvt_pk_bf16_f32 v130, v132, v133
  v_cvt_pk_bf16_f32 v131, v134, v135
  buffer_store_dwordx4 v[128:131], v11, s[36:39], s22 offen offset:2048 sc1
  v_cvt_pk_bf16_f32 v132, v136, v137
  v_cvt_pk_bf16_f32 v133, v138, v139
  v_cvt_pk_bf16_f32 v134, v140, v141
  v_cvt_pk_bf16_f32 v135, v142, v143
  buffer_store_dwordx4 v[132:135], v11, s[36:39], s22 offen offset:3072 sc1
L_join:
  s_waitcnt vmcnt(0) lgkmcnt(0)
  s_buffer_atomic_swap s68, s[36:39], s23
  s_waitcnt vmcnt(0) lgkmcnt(0)
  s_endpgm
L_t3:
  s_waitcnt lgkmcnt(8)
  ds_read_b64_tr_b16 v[188:189], v6 offset:24576
  ds_read_b64_tr_b16 v[190:191], v6 offset:26624
  v_cvt_pk_bf16_f32 v80, v80, v81
  v_cvt_pk_bf16_f32 v81, v82, v83
  v_cvt_pk_bf16_f32 v82, v84, v85
  v_cvt_pk_bf16_f32 v83, v86, v87
  ds_write_b128 v254, v[80:83] offset:0
  v_mfma_f32_32x32x16_bf16 v[96:111], v[200:203], v[152:155], v[96:111]
  s_waitcnt lgkmcnt(9)
  ds_read_b64_tr_b16 v[192:193], v7 offset:12288
  ds_read_b64_tr_b16 v[194:195], v7 offset:14336
  v_cvt_pk_bf16_f32 v84, v88, v89
  v_cvt_pk_bf16_f32 v85, v90, v91
  v_cvt_pk_bf16_f32 v86, v92, v93
  v_cvt_pk_bf16_f32 v87, v94, v95
  ds_write_b128 v254, v[84:87] offset:1024
  v_mfma_f32_32x32x16_bf16 v[96:111], v[204:207], v[156:159], v[96:111]
  s_waitcnt lgkmcnt(10)
  ds_read_b64_tr_b16 v[196:197], v7 offset:16384
  ds_read_b64_tr_b16 v[198:199], v7 offset:18432
  v_mfma_f32_32x32x16_bf16 v[112:127], v[176:179], v[232:235], v[112:127]
  s_waitcnt lgkmcnt(10)
  ds_read_b64_tr_b16 v[200:201], v7 offset:20480
  ds_read_b64_tr_b16 v[202:203], v7 offset:22528
  v_mfma_f32_32x32x16_bf16 v[112:127], v[180:183], v[236:239], v[112:127]
  s_waitcnt lgkmcnt(10)
  ds_read_b64_tr_b16 v[204:205], v7 offset:24576
  ds_read_b64_tr_b16 v[206:207], v7 offset:26624
  v_cvt_pk_bf16_f32 v96, v96, v97
  v_cvt_pk_bf16_f32 v97, v98, v99
  v_cvt_pk_bf16_f32 v98, v100, v101
  v_cvt_pk_bf16_f32 v99, v102, v103
  ds_write_b128 v254, v[96:99] offset:2048
  v_mfma_f32_32x32x16_bf16 v[112:127], v[184:187], v[152:155], v[112:127]
  s_waitcnt lgkmcnt(11)
  v_cvt_pk_bf16_f32 v100, v104, v105
  v_cvt_pk_bf16_f32 v101, v106, v107
  v_cvt_pk_bf16_f32 v102, v108, v109
  v_cvt_pk_bf16_f32 v103, v110, v111
  ds_write_b128 v254, v[100:103] offset:3072
  v_mfma_f32_32x32x16_bf16 v[112:127], v[188:191], v[156:159], v[112:127]
  s_waitcnt lgkmcnt(9)
  v_mfma_f32_32x32x16_bf16 v[128:143], v[192:195], v[232:235], v[128:143]
  s_waitcnt lgkmcnt(6)
  v_mfma_f32_32x32x16_bf16 v[128:143], v[196:199], v[236:239], v[128:143]
  s_waitcnt lgkmcnt(4)
  v_cvt_pk_bf16_f32 v112, v112, v113
  v_cvt_pk_bf16_f32 v113, v114, v115
  v_cvt_pk_bf16_f32 v114, v116, v117
  v_cvt_pk_bf16_f32 v115, v118, v119
  ds_write_b128 v254, v[112:115] offset:4096
  v_mfma_f32_32x32x16_bf16 v[128:143], v[200:203], v[152:155], v[128:143]
  s_waitcnt lgkmcnt(3)
  v_cvt_pk_bf16_f32 v116, v120, v121
  v_cvt_pk_bf16_f32 v117, v122, v123
  v_cvt_pk_bf16_f32 v118, v124, v125
  v_cvt_pk_bf16_f32 v119, v126, v127
  ds_write_b128 v254, v[116:119] offset:5120
  v_mfma_f32_32x32x16_bf16 v[128:143], v[204:207], v[156:159], v[128:143]
s_nop 11
  v_cvt_pk_bf16_f32 v128, v128, v129
  v_cvt_pk_bf16_f32 v129, v130, v131
  v_cvt_pk_bf16_f32 v130, v132, v133
  v_cvt_pk_bf16_f32 v131, v134, v135
  ds_write_b128 v254, v[128:131] offset:6144
  v_cvt_pk_bf16_f32 v132, v136, v137
  v_cvt_pk_bf16_f32 v133, v138, v139
  v_cvt_pk_bf16_f32 v134, v140, v141
  v_cvt_pk_bf16_f32 v135, v142, v143
  ds_write_b128 v254, v[132:135] offset:7168
  s_branch L_join
slow_g256:
  ds_read_b32 v3, v1 offset:256
  s_add_u32 s67, s67, 1
  s_waitcnt lgkmcnt(0)
  v_cmp_ne_u32 vcc, 0, v3
  s_cmp_ge_u32 s67, 131072
  s_cbranch_scc1 back_g256
  s_cbranch_vccnz slow_g256
  s_branch back_g256
slow_g272:
  ds_read_b32 v3, v1 offset:272
  s_add_u32 s67, s67, 1
  s_waitcnt lgkmcnt(0)
  v_cmp_ne_u32 vcc, 0, v3
  s_cmp_ge_u32 s67, 131072
  s_cbranch_scc1 back_g272
  s_cbranch_vccnz slow_g272
  s_branch back_g272
slow_g288:
  ds_read_b32 v3, v1 offset:288
  s_add_u32 s67, s67, 1
  s_waitcnt lgkmcnt(0)
  v_cmp_ne_u32 vcc, 0, v3
  s_cmp_ge_u32 s67, 131072
  s_cbranch_scc1 back_g288
  s_cbranch_vccnz slow_g288
  s_branch back_g288
slow_g304:
  ds_read_b32 v3, v1 offset:304
  s_add_u32 s67, s67, 1
  s_waitcnt lgkmcnt(0)
  v_cmp_ne_u32 vcc, 0, v3
  s_cmp_ge_u32 s67, 131072
  s_cbranch_scc1 back_g304
  s_cbranch_vccnz slow_g304
  s_branch back_g304
slow_g320:
  ds_read_b32 v3, v1 offset:320
  s_add_u32 s67, s67, 1
  s_waitcnt lgkmcnt(0)
  v_cmp_ne_u32 vcc, 0, v3
  s_cmp_ge_u32 s67, 131072
  s_cbranch_scc1 back_g320
  s_cbranch_vccnz slow_g320
  s_branch back_g320
slow_g336:
  ds_read_b32 v3, v1 offset:336
  s_add_u32 s67, s67, 1
  s_waitcnt lgkmcnt(0)
  v_cmp_ne_u32 vcc, 0, v3
  s_cmp_ge_u32 s67, 131072
  s_cbranch_scc1 back_g336
  s_cbranch_vccnz slow_g336
  s_branch back_g336
slow_g352:
  ds_read_b32 v3, v1 offset:352
  s_add_u32 s67, s67, 1
  s_waitcnt lgkmcnt(0)
  v_cmp_ne_u32 vcc, 0, v3
  s_cmp_ge_u32 s67, 131072
  s_cbranch_scc1 back_g352
  s_cbranch_vccnz slow_g352
  s_branch back_g352
slow_g368:
  ds_read_b32 v3, v1 offset:368
  s_add_u32 s67, s67, 1
  s_waitcnt lgkmcnt(0)
  v_cmp_ne_u32 vcc, 0, v3
  s_cmp_ge_u32 s67, 131072
  s_cbranch_scc1 back_g368
  s_cbranch_vccnz slow_g368
  s_branch back_g368
slow_g384:
  ds_read_b32 v3, v1 offset:384
  s_add_u32 s67, s67, 1
  s_waitcnt lgkmcnt(0)
  v_cmp_ne_u32 vcc, 0, v3
  s_cmp_ge_u32 s67, 131072
  s_cbranch_scc1 back_g384
  s_cbranch_vccnz slow_g384
  s_branch back_g384
slow_g400:
  ds_read_b32 v3, v1 offset:400
  s_add_u32 s67, s67, 1
  s_waitcnt lgkmcnt(0)
  v_cmp_ne_u32 vcc, 0, v3
  s_cmp_ge_u32 s67, 131072
  s_cbranch_scc1 back_g400
  s_cbranch_vccnz slow_g400
  s_branch back_g400
slow_g416:
  ds_read_b32 v3, v1 offset:416
  s_add_u32 s67, s67, 1
  s_waitcnt lgkmcnt(0)
  v_cmp_ne_u32 vcc, 0, v3
  s_cmp_ge_u32 s67, 131072
  s_cbranch_scc1 back_g416
  s_cbranch_vccnz slow_g416
  s_branch back_g416
slow_g432:
  ds_read_b32 v3, v1 offset:432
  s_add_u32 s67, s67, 1
  s_waitcnt lgkmcnt(0)
  v_cmp_ne_u32 vcc, 0, v3
  s_cmp_ge_u32 s67, 131072
  s_cbranch_scc1 back_g432
  s_cbranch_vccnz slow_g432
  s_branch back_g432
slow_g512:
  ds_read_b32 v3, v1 offset:512
  s_add_u32 s67, s67, 1
  s_waitcnt lgkmcnt(0)
  v_cmp_ne_u32 vcc, 0, v3
  s_cmp_ge_u32 s67, 131072
  s_cbranch_scc1 back_g512
  s_cbranch_vccnz slow_g512
  s_branch back_g512
slow_g528:
  ds_read_b32 v3, v1 offset:528
  s_add_u32 s67, s67, 1
  s_waitcnt lgkmcnt(0)
  v_cmp_ne_u32 vcc, 0, v3
  s_cmp_ge_u32 s67, 131072
  s_cbranch_scc1 back_g528
  s_cbranch_vccnz slow_g528
  s_branch back_g528
slow_g544:
  ds_read_b32 v3, v1 offset:544
  s_add_u32 s67, s67, 1
  s_waitcnt lgkmcnt(0)
  v_cmp_ne_u32 vcc, 0, v3
  s_cmp_ge_u32 s67, 131072
  s_cbranch_scc1 back_g544
  s_cbranch_vccnz slow_g544
  s_branch back_g544
slow_g560:
  ds_read_b32 v3, v1 offset:560
  s_add_u32 s67, s67, 1
  s_waitcnt lgkmcnt(0)
  v_cmp_ne_u32 vcc, 0, v3
  s_cmp_ge_u32 s67, 131072
  s_cbranch_scc1 back_g560
  s_cbranch_vccnz slow_g560
  s_branch back_g560
slow_g576:
  ds_read_b32 v3, v1 offset:576
  s_add_u32 s67, s67, 1
  s_waitcnt lgkmcnt(0)
  v_cmp_ne_u32 vcc, 0, v3
  s_cmp_ge_u32 s67, 131072
  s_cbranch_scc1 back_g576
  s_cbranch_vccnz slow_g576
  s_branch back_g576
slow_g592:
  ds_read_b32 v3, v1 offset:592
  s_add_u32 s67, s67, 1
  s_waitcnt lgkmcnt(0)
  v_cmp_ne_u32 vcc, 0, v3
  s_cmp_ge_u32 s67, 131072
  s_cbranch_scc1 back_g592
  s_cbranch_vccnz slow_g592
  s_branch back_g592
slow_g608:
  ds_read_b32 v3, v1 offset:608
  s_add_u32 s67, s67, 1
  s_waitcnt lgkmcnt(0)
  v_cmp_ne_u32 vcc, 0, v3
  s_cmp_ge_u32 s67, 131072
  s_cbranch_scc1 back_g608
  s_cbranch_vccnz slow_g608
  s_branch back_g608
slow_h0:
  s_waitcnt lgkmcnt(0)
  s_xor_b64 s[8:9], s[48:49], s[68:69]
  s_xor_b64 s[10:11], s[50:51], s[68:69]
  s_or_b64 s[8:9], s[8:9], s[10:11]
  s_cbranch_scc0 back_h0
  s_buffer_load_dwordx4 s[48:51], s[36:39], s7 offset:0 glc
  s_add_u32 s67, s67, 8
  s_cmp_lt_u32 s67, 131072
  s_cbranch_scc1 slow_h0
  s_branch back_h0
slow_h1:
  s_waitcnt lgkmcnt(0)
  s_xor_b64 s[8:9], s[52:53], s[68:69]
  s_xor_b64 s[10:11], s[54:55], s[68:69]
  s_or_b64 s[8:9], s[8:9], s[10:11]
  s_cbranch_scc0 back_h1
  s_buffer_load_dwordx4 s[52:55], s[36:39], s7 offset:16 glc
  s_add_u32 s67, s67, 8
  s_cmp_lt_u32 s67, 131072
  s_cbranch_scc1 slow_h1
  s_branch back_h1
slow_h2:
  s_waitcnt lgkmcnt(0)
  s_xor_b64 s[8:9], s[56:57], s[68:69]
  s_xor_b64 s[10:11], s[58:59], s[68:69]
  s_or_b64 s[8:9], s[8:9], s[10:11]
  s_cbranch_scc0 back_h2
  s_buffer_load_dwordx4 s[56:59], s[36:39], s7 offset:32 glc
  s_add_u32 s67, s67, 8
  s_cmp_lt_u32 s67, 131072
  s_cbranch_scc1 slow_h2
  s_branch back_h2
slow_h3:
  s_waitcnt lgkmcnt(0)
  s_xor_b64 s[8:9], s[32:33], s[68:69]
  s_xor_b64 s[10:11], s[34:35], s[68:69]
  s_or_b64 s[8:9], s[8:9], s[10:11]
  s_cbranch_scc0 back_h3
  s_buffer_load_dwordx4 s[32:35], s[36:39], s7 offset:48 glc
  s_add_u32 s67, s67, 8
  s_cmp_lt_u32 s67, 131072
  s_cbranch_scc1 slow_h3
  s_branch back_h3
slow_g48:
  ds_read_b32 v3, v1 offset:48
  s_add_u32 s67, s67, 1
  s_waitcnt lgkmcnt(0)
  v_cmp_gt_u32 vcc, 3, v3
  s_cmp_ge_u32 s67, 131072
  s_cbranch_scc1 back_g48
  s_cbranch_vccnz slow_g48
  s_branch back_g48
L_F:
  s_cmp_lg_u32 s60, 7
  s_cbranch_scc1 L_nopf
  s_getpc_b64 s[10:11]
L_pc:
  v_and_b32 v248, 15, v0
  s_lshl_b32 s3, s62, 4
  v_add_lshl_u32 v248, v248, s3, 7
  s_sub_u32 s10, s10, L_pc-gated_mix__spectral_gfnet__dense_activation_silu__prompt_kernel
  s_subb_u32 s11, s11, 0
  v_min_u32 v248, L_end-gated_mix__spectral_gfnet__dense_activation_silu__prompt_kernel, v248
  global_load_dword v247, v248, s[10:11]
  v_lshrrev_b32 v252, 4, v0
  v_lshrrev_b32 v253, 4, v0
  v_lshrrev_b32 v254, 4, v0
  v_lshrrev_b32 v255, 4, v0
  v_add_u32 v250, 159744, v2
  ds_write_b128 v250, v[252:255]
L_nopf:
  s_load_dwordx2 s[32:33], s[0:1], 32
  s_load_dwordx2 s[52:53], s[0:1], 40
  s_load_dwordx2 s[44:45], s[0:1], 8
  s_load_dwordx2 s[48:49], s[0:1], 16
  s_load_dwordx2 s[56:57], s[0:1], 56
  s_sub_u32 s4, s60, 4
  v_lshrrev_b32 v5, 5, v0
  v_and_b32 v6, 31, v0
  s_lshr_b32 s5, s64, 2
  s_and_b32 s6, s64, 3
  s_lshl2_add_u32 s7, s63, s5
  s_and_b32 s8, s4, 1
  s_lshr_b32 s3, s2, 6
  s_lshl2_add_u32 s9, s61, s3
  s_mov_b32 s34, 0x1c0000
  s_mov_b32 s35, 0x20000
  s_mov_b32 s54, 0x1c0000
  s_mov_b32 s55, 0x20000
  s_mov_b32 s46, 0x101000
  s_mov_b32 s47, 0x20000
  s_mov_b32 s50, 0x101000
  s_mov_b32 s51, 0x20000
  s_mov_b32 s58, 0x200000
  s_mov_b32 s59, 0x20000
  v_and_b32 v1, 3, v0
  v_lshlrev_b32 v1, 2, v1
  v_add_u32 v1, 159744, v1
  s_lshl3_add_u32 s3, s8, 159744
  v_mov_b32 v4, s3
  s_cmp_ge_u32 s4, 2
  s_cbranch_scc1 L_F23
  s_lshl3_add_u32 s3, s9, s66
  s_andn2_b32 s3, s3, 24
  s_lshl_b32 s13, s3, 9
  s_add_u32 s13, s13, 0x14c0000
  v_cvt_f32_u32 v8, v6
  v_mul_f32 v8, 0xbd000000, v8
  v_lshlrev_b32 v9, 2, v5
  v_cvt_f32_u32 v9, v9
  v_mul_f32 v7, v9, v8
  s_lshl_b32 s3, s4, 31
  s_xor_b32 s18, s3, 0xbc800000
  s_xor_b32 s19, s3, 0xbda00000
  v_cos_f32 v248, v7
  v_sin_f32 v252, v7
  v_add_f32 v7, v7, v8
  v_cos_f32 v249, v7
  v_sin_f32 v253, v7
  v_add_f32 v7, v7, v8
  v_cos_f32 v250, v7
  v_sin_f32 v254, v7
  v_add_f32 v7, v7, v8
  v_cos_f32 v251, v7
  v_sin_f32 v255, v7
  v_add_f32 v7, v7, v8
  v_cvt_pk_bf16_f32 v114, v248, v249
  v_cvt_pk_bf16_f32 v112, v252, v253
  v_cvt_pk_bf16_f32 v115, v250, v251
  v_cvt_pk_bf16_f32 v113, v254, v255
  v_fma_f32 v7, v8, 4.0, v7
  v_xor_b32 v116, 0x80008000, v112
  v_xor_b32 v117, 0x80008000, v113
  s_lshl_b32 s3, s4, 8
  s_add_u32 s3, s3, s13
  s_waitcnt lgkmcnt(0)
  s_buffer_load_dword s68, s[36:39], 0
  s_buffer_load_dword s20, s[36:39], s3 offset:0 glc
  s_buffer_load_dword s21, s[36:39], s3 offset:128 glc
  s_cmp_eq_u32 s4, 0
  s_cselect_b64 s[44:45], s[44:45], s[48:49]
  s_lshl_b32 s23, s66, 8
  s_add_u32 s23, s23, s9
  s_mul_i32 s23, s23, 514
  s_andn2_b32 s23, s23, 3
  v_cos_f32 v248, v7
  v_sin_f32 v252, v7
  v_add_f32 v7, v7, v8
  v_cos_f32 v249, v7
  v_sin_f32 v253, v7
  v_add_f32 v7, v7, v8
  v_cos_f32 v250, v7
  v_sin_f32 v254, v7
  v_add_f32 v7, v7, v8
  v_cos_f32 v251, v7
  v_sin_f32 v255, v7
  v_add_f32 v7, v7, v8
  v_cvt_pk_bf16_f32 v120, v248, v249
  v_cvt_pk_bf16_f32 v118, v252, v253
  v_cvt_pk_bf16_f32 v121, v250, v251
  v_cvt_pk_bf16_f32 v119, v254, v255
  v_fma_f32 v7, v8, 4.0, v7
  v_xor_b32 v122, 0x80008000, v118
  v_xor_b32 v123, 0x80008000, v119
  v_cos_f32 v248, v7
  v_sin_f32 v252, v7
  v_add_f32 v7, v7, v8
  v_cos_f32 v249, v7
  v_sin_f32 v253, v7
  v_add_f32 v7, v7, v8
  v_cos_f32 v250, v7
  v_sin_f32 v254, v7
  v_add_f32 v7, v7, v8
  v_cos_f32 v251, v7
  v_sin_f32 v255, v7
  v_add_f32 v7, v7, v8
  v_cvt_pk_bf16_f32 v126, v248, v249
  v_cvt_pk_bf16_f32 v124, v252, v253
  v_cvt_pk_bf16_f32 v127, v250, v251
  v_cvt_pk_bf16_f32 v125, v254, v255
  v_fma_f32 v7, v8, 4.0, v7
  v_xor_b32 v128, 0x80008000, v124
  v_xor_b32 v129, 0x80008000, v125
  v_cos_f32 v248, v7
  v_sin_f32 v252, v7
  v_add_f32 v7, v7, v8
  v_cos_f32 v249, v7
  v_sin_f32 v253, v7
  v_add_f32 v7, v7, v8
  v_cos_f32 v250, v7
  v_sin_f32 v254, v7
  v_add_f32 v7, v7, v8
  v_cos_f32 v251, v7
  v_sin_f32 v255, v7
  v_add_f32 v7, v7, v8
  v_cvt_pk_bf16_f32 v132, v248, v249
  v_cvt_pk_bf16_f32 v130, v252, v253
  v_cvt_pk_bf16_f32 v133, v250, v251
  v_cvt_pk_bf16_f32 v131, v254, v255
  v_xor_b32 v134, 0x80008000, v130
  v_xor_b32 v135, 0x80008000, v131
  v_mul_f32 v7, s18, v9
  v_cos_f32 v20, v7
  v_sin_f32 v68, v7
  v_add_f32 v7, s18, v7
  v_cos_f32 v21, v7
  v_sin_f32 v69, v7
  v_add_f32 v7, s18, v7
  v_cos_f32 v26, v7
  v_sin_f32 v74, v7
  v_add_f32 v7, s18, v7
  v_cos_f32 v27, v7
  v_sin_f32 v75, v7
  v_add_f32 v7, s19, v7
  s_barrier
  v_cos_f32 v32, v7
  v_sin_f32 v80, v7
  v_add_f32 v7, s18, v7
  v_cos_f32 v33, v7
  v_sin_f32 v81, v7
  v_add_f32 v7, s18, v7
  v_cos_f32 v38, v7
  v_sin_f32 v86, v7
  v_add_f32 v7, s18, v7
  v_cos_f32 v39, v7
  v_sin_f32 v87, v7
  v_add_f32 v7, s19, v7
  v_cos_f32 v44, v7
  v_sin_f32 v92, v7
  v_add_f32 v7, s18, v7
  v_cos_f32 v45, v7
  v_sin_f32 v93, v7
  v_add_f32 v7, s18, v7
  v_cos_f32 v50, v7
  v_sin_f32 v98, v7
  v_add_f32 v7, s18, v7
  v_cos_f32 v51, v7
  v_sin_f32 v99, v7
  v_add_f32 v7, s19, v7
  v_cos_f32 v56, v7
  v_sin_f32 v104, v7
  v_add_f32 v7, s18, v7
  v_cos_f32 v57, v7
  v_sin_f32 v105, v7
  v_add_f32 v7, s18, v7
  v_cos_f32 v62, v7
  v_sin_f32 v110, v7
  v_add_f32 v7, s18, v7
  v_cos_f32 v63, v7
  v_sin_f32 v111, v7
  s_lshl2_add_u32 s3, s6, s4
  s_lshl_b32 s3, s3, 4
  v_xor_b32 v8, s3, v6
  v_cvt_f32_u32 v8, v8
  v_mul_f32 v8, 0x3b800000, v8
  v_lshl_add_u32 v7, v5, 2, s8
  v_cmp_eq_u32 vcc, 0, v7
  v_cvt_f32_u32 v7, v7
  v_mul_f32 v7, 0.5, v7
  v_cndmask_b32 v9, 1.0, 0.5, vcc
  v_mul_f32 v7, v7, v8
  v_mul_f32 v10, 0x40400000, v8
  v_cos_f32 v248, v7
  v_sin_f32 v252, v7
  v_add_f32 v7, v7, v8
  v_cos_f32 v249, v7
  v_sin_f32 v253, v7
  v_add_f32 v7, v7, v10
  v_mul_f32 v248, v248, v9
  v_cos_f32 v250, v7
  v_sin_f32 v254, v7
  v_add_f32 v7, v7, v8
  v_cos_f32 v251, v7
  v_sin_f32 v255, v7
  v_add_f32 v7, v7, v10
  v_cvt_pk_bf16_f32 v18, v248, v249
  v_cvt_pk_bf16_f32 v16, v252, v253
  v_cvt_pk_bf16_f32 v19, v250, v251
  v_cvt_pk_bf16_f32 v17, v254, v255
  v_cos_f32 v248, v7
  v_sin_f32 v252, v7
  v_add_f32 v7, v7, v8
  v_cos_f32 v249, v7
  v_sin_f32 v253, v7
  v_add_f32 v7, v7, v10
  v_cos_f32 v250, v7
  v_sin_f32 v254, v7
  v_add_f32 v7, v7, v8
  v_cos_f32 v251, v7
  v_sin_f32 v255, v7
  v_add_f32 v7, v7, v10
  v_cvt_pk_bf16_f32 v24, v248, v249
  v_cvt_pk_bf16_f32 v22, v252, v253
  v_cvt_pk_bf16_f32 v25, v250, v251
  v_cvt_pk_bf16_f32 v23, v254, v255
  v_cos_f32 v248, v7
  v_sin_f32 v252, v7
  v_add_f32 v7, v7, v8
  v_cos_f32 v249, v7
  v_sin_f32 v253, v7
  v_add_f32 v7, v7, v10
  v_cos_f32 v250, v7
  v_sin_f32 v254, v7
  v_add_f32 v7, v7, v8
  v_cos_f32 v251, v7
  v_sin_f32 v255, v7
  v_add_f32 v7, v7, v10
  v_cvt_pk_bf16_f32 v30, v248, v249
  v_cvt_pk_bf16_f32 v28, v252, v253
  v_cvt_pk_bf16_f32 v31, v250, v251
  v_cvt_pk_bf16_f32 v29, v254, v255
  v_cos_f32 v248, v7
  v_sin_f32 v252, v7
  v_add_f32 v7, v7, v8
  v_cos_f32 v249, v7
  v_sin_f32 v253, v7
  v_add_f32 v7, v7, v10
  v_cos_f32 v250, v7
  v_sin_f32 v254, v7
  v_add_f32 v7, v7, v8
  v_cos_f32 v251, v7
  v_sin_f32 v255, v7
  v_add_f32 v7, v7, v10
  v_cvt_pk_bf16_f32 v36, v248, v249
  v_cvt_pk_bf16_f32 v34, v252, v253
  v_cvt_pk_bf16_f32 v37, v250, v251
  v_cvt_pk_bf16_f32 v35, v254, v255
  v_cos_f32 v248, v7
  v_sin_f32 v252, v7
  v_add_f32 v7, v7, v8
  v_cos_f32 v249, v7
  v_sin_f32 v253, v7
  v_add_f32 v7, v7, v10
  v_cos_f32 v250, v7
  v_sin_f32 v254, v7
  v_add_f32 v7, v7, v8
  v_cos_f32 v251, v7
  v_sin_f32 v255, v7
  v_add_f32 v7, v7, v10
  v_cvt_pk_bf16_f32 v42, v248, v249
  v_cvt_pk_bf16_f32 v40, v252, v253
  v_cvt_pk_bf16_f32 v43, v250, v251
  v_cvt_pk_bf16_f32 v41, v254, v255
  v_cos_f32 v248, v7
  v_sin_f32 v252, v7
  v_add_f32 v7, v7, v8
  v_cos_f32 v249, v7
  v_sin_f32 v253, v7
  v_add_f32 v7, v7, v10
  v_cos_f32 v250, v7
  v_sin_f32 v254, v7
  v_add_f32 v7, v7, v8
  v_cos_f32 v251, v7
  v_sin_f32 v255, v7
  v_add_f32 v7, v7, v10
  v_cvt_pk_bf16_f32 v48, v248, v249
  v_cvt_pk_bf16_f32 v46, v252, v253
  v_cvt_pk_bf16_f32 v49, v250, v251
  v_cvt_pk_bf16_f32 v47, v254, v255
  v_cos_f32 v248, v7
  v_sin_f32 v252, v7
  v_add_f32 v7, v7, v8
  v_cos_f32 v249, v7
  v_sin_f32 v253, v7
  v_add_f32 v7, v7, v10
  v_cos_f32 v250, v7
  v_sin_f32 v254, v7
  v_add_f32 v7, v7, v8
  v_cos_f32 v251, v7
  v_sin_f32 v255, v7
  v_add_f32 v7, v7, v10
  v_cvt_pk_bf16_f32 v54, v248, v249
  v_cvt_pk_bf16_f32 v52, v252, v253
  v_cvt_pk_bf16_f32 v55, v250, v251
  v_cvt_pk_bf16_f32 v53, v254, v255
  v_cos_f32 v248, v7
  v_sin_f32 v252, v7
  v_add_f32 v7, v7, v8
  v_cos_f32 v249, v7
  v_sin_f32 v253, v7
  v_add_f32 v7, v7, v10
  v_cos_f32 v250, v7
  v_sin_f32 v254, v7
  v_add_f32 v7, v7, v8
  v_cos_f32 v251, v7
  v_sin_f32 v255, v7
  v_add_f32 v7, v7, v10
  v_cvt_pk_bf16_f32 v60, v248, v249
  v_cvt_pk_bf16_f32 v58, v252, v253
  v_cvt_pk_bf16_f32 v61, v250, v251
  v_cvt_pk_bf16_f32 v59, v254, v255
  v_cos_f32 v248, v7
  v_sin_f32 v252, v7
  v_add_f32 v7, v7, v8
  v_cos_f32 v249, v7
  v_sin_f32 v253, v7
  v_add_f32 v7, v7, v10
  v_cos_f32 v250, v7
  v_sin_f32 v254, v7
  v_add_f32 v7, v7, v8
  v_cos_f32 v251, v7
  v_sin_f32 v255, v7
  v_add_f32 v7, v7, v10
  v_cvt_pk_bf16_f32 v66, v248, v249
  v_cvt_pk_bf16_f32 v64, v252, v253
  v_cvt_pk_bf16_f32 v67, v250, v251
  v_cvt_pk_bf16_f32 v65, v254, v255
  v_cos_f32 v248, v7
  v_sin_f32 v252, v7
  v_add_f32 v7, v7, v8
  v_cos_f32 v249, v7
  v_sin_f32 v253, v7
  v_add_f32 v7, v7, v10
  v_cos_f32 v250, v7
  v_sin_f32 v254, v7
  v_add_f32 v7, v7, v8
  v_cos_f32 v251, v7
  v_sin_f32 v255, v7
  v_add_f32 v7, v7, v10
  v_cvt_pk_bf16_f32 v72, v248, v249
  v_cvt_pk_bf16_f32 v70, v252, v253
  v_cvt_pk_bf16_f32 v73, v250, v251
  v_cvt_pk_bf16_f32 v71, v254, v255
  v_cos_f32 v248, v7
  v_sin_f32 v252, v7
  v_add_f32 v7, v7, v8
  v_cos_f32 v249, v7
  v_sin_f32 v253, v7
  v_add_f32 v7, v7, v10
  v_cos_f32 v250, v7
  v_sin_f32 v254, v7
  v_add_f32 v7, v7, v8
  v_cos_f32 v251, v7
  v_sin_f32 v255, v7
  v_add_f32 v7, v7, v10
  v_cvt_pk_bf16_f32 v78, v248, v249
  v_cvt_pk_bf16_f32 v76, v252, v253
  v_cvt_pk_bf16_f32 v79, v250, v251
  v_cvt_pk_bf16_f32 v77, v254, v255
  v_cos_f32 v248, v7
  v_sin_f32 v252, v7
  v_add_f32 v7, v7, v8
  v_cos_f32 v249, v7
  v_sin_f32 v253, v7
  v_add_f32 v7, v7, v10
  v_cos_f32 v250, v7
  v_sin_f32 v254, v7
  v_add_f32 v7, v7, v8
  v_cos_f32 v251, v7
  v_sin_f32 v255, v7
  v_add_f32 v7, v7, v10
  v_cvt_pk_bf16_f32 v84, v248, v249
  v_cvt_pk_bf16_f32 v82, v252, v253
  v_cvt_pk_bf16_f32 v85, v250, v251
  v_cvt_pk_bf16_f32 v83, v254, v255
  v_cos_f32 v248, v7
  v_sin_f32 v252, v7
  v_add_f32 v7, v7, v8
  v_cos_f32 v249, v7
  v_sin_f32 v253, v7
  v_add_f32 v7, v7, v10
  v_cos_f32 v250, v7
  v_sin_f32 v254, v7
  v_add_f32 v7, v7, v8
  v_cos_f32 v251, v7
  v_sin_f32 v255, v7
  v_add_f32 v7, v7, v10
  v_cvt_pk_bf16_f32 v90, v248, v249
  v_cvt_pk_bf16_f32 v88, v252, v253
  v_cvt_pk_bf16_f32 v91, v250, v251
  v_cvt_pk_bf16_f32 v89, v254, v255
  v_cos_f32 v248, v7
  v_sin_f32 v252, v7
  v_add_f32 v7, v7, v8
  v_cos_f32 v249, v7
  v_sin_f32 v253, v7
  v_add_f32 v7, v7, v10
  v_cos_f32 v250, v7
  v_sin_f32 v254, v7
  v_add_f32 v7, v7, v8
  v_cos_f32 v251, v7
  v_sin_f32 v255, v7
  v_add_f32 v7, v7, v10
  v_cvt_pk_bf16_f32 v96, v248, v249
  v_cvt_pk_bf16_f32 v94, v252, v253
  v_cvt_pk_bf16_f32 v97, v250, v251
  v_cvt_pk_bf16_f32 v95, v254, v255
  v_cos_f32 v248, v7
  v_sin_f32 v252, v7
  v_add_f32 v7, v7, v8
  v_cos_f32 v249, v7
  v_sin_f32 v253, v7
  v_add_f32 v7, v7, v10
  v_cos_f32 v250, v7
  v_sin_f32 v254, v7
  v_add_f32 v7, v7, v8
  v_cos_f32 v251, v7
  v_sin_f32 v255, v7
  v_add_f32 v7, v7, v10
  v_cvt_pk_bf16_f32 v102, v248, v249
  v_cvt_pk_bf16_f32 v100, v252, v253
  v_cvt_pk_bf16_f32 v103, v250, v251
  v_cvt_pk_bf16_f32 v101, v254, v255
  v_cos_f32 v248, v7
  v_sin_f32 v252, v7
  v_add_f32 v7, v7, v8
  v_cos_f32 v249, v7
  v_sin_f32 v253, v7
  v_add_f32 v7, v7, v10
  v_cos_f32 v250, v7
  v_sin_f32 v254, v7
  v_add_f32 v7, v7, v8
  v_cos_f32 v251, v7
  v_sin_f32 v255, v7
  v_add_f32 v7, v7, v10
  v_cvt_pk_bf16_f32 v108, v248, v249
  v_cvt_pk_bf16_f32 v106, v252, v253
  v_cvt_pk_bf16_f32 v109, v250, v251
  v_cvt_pk_bf16_f32 v107, v254, v255
  v_and_b32 v248, 16, v0
  v_and_b32 v249, 0xc0, v2
  v_and_b32 v250, 3, v0
  v_lshl_add_u32 v7, v5, 8, v249
  v_lshl_add_u32 v7, v248, 1, v7
  v_lshl_add_u32 v7, v250, 3, v7
  v_add_u32 v7, 151552, v7
  v_and_b32 v11, 0x3d0, v2
  v_lshl_add_u32 v11, v248, 1, v11
  v_and_b32 v250, 2, v0
  s_lshl_b32 s18, s4, 12
  s_lshl_b32 s19, s4, 13
  s_sub_u32 s19, 0x1000, s19
  s_add_u32 s18, s18, 143360
  v_lshl_add_u32 v11, v250, 2, v11
  v_add_u32 v11, s18, v11
  v_xor_b32 v12, 32, v11
  v_lshlrev_b32 v250, 1, v248
  v_xor_b32 v250, v250, v2
  v_and_b32 v250, 0x270, v250
  v_lshl_add_u32 v250, v248, 8, v250
  v_and_b32 v249, 8, v0
  v_lshl_add_u32 v10, v249, 5, v250
  s_lshl3_add_u32 s3, s9, s66
  s_lshl_b32 s3, s3, 6
  s_add_u32 s3, s3, s4
  s_lshl_b32 s3, s3, 7
  s_add_u32 s10, s3, 0x10000
  v_and_b32 v249, 28, v0
  v_mul_u32_u24 v13, 65792, v249
  v_lshl_add_u32 v13, v5, 6, v13
  v_and_or_b32 v13, v2, 48, v13
  s_mul_i32 s11, s4, 257
  s_lshl_b32 s3, s66, 5
  s_add_u32 s3, s3, s9
  s_add_u32 s11, s11, s3
  s_lshl_b32 s11, s11, 7
  s_add_u32 s11, s11, 0x210000
  v_lshlrev_b32 v8, 12, v0
  v_mov_b32 v14, v8
  s_lshr_b32 s3, s3, 4
  s_lshl4_add_u32 s3, s4, s3
  s_lshl_b32 s3, s3, 7
  s_add_u32 s12, s3, 0x1450000
  s_lshl_b32 s3, s4, 8
  s_add_u32 s3, s3, s64
  s_lshl4_add_u32 s3, s3, s63
  s_lshl_b32 s16, s3, 4
  s_andn2_b32 s16, s16, 127
  s_and_b32 s3, s63, 7
  s_lshl2_add_u32 s16, s3, s16
  s_add_u32 s16, s16, 0x14c0000
  s_lshl3_add_u32 s17, s4, 159744
  s_mov_b64 s[14:15], 0
  v_mov_b32 v15, 1
  s_waitcnt lgkmcnt(0)
  s_and_b32 s68, s68, -16
  s_add_u32 s68, s68, 17
  s_mov_b32 s69, s68
  v_mov_b32 v9, s68
L_wf:
  ds_read_b32 v3, v1 offset:848
  ds_read_b32 v248, v1 offset:992
  s_waitcnt lgkmcnt(1)
  v_cmp_ne_u32 vcc, 0, v3
s_nop 0
  s_or_b64 vcc, vcc, s[14:15]
  s_cbranch_scc1 snd22
  s_buffer_atomic_swap s68, s[36:39], s16 offset:0
  s_buffer_atomic_swap s68, s[36:39], s16 offset:16384
  s_buffer_atomic_swap s68, s[36:39], s16 offset:32768
  s_buffer_atomic_swap s68, s[36:39], s16 offset:49152
  s_mov_b64 s[14:15], -1
snd22:
  s_add_u32 s67, s67, 1
  s_waitcnt lgkmcnt(0)
  v_cmp_ne_u32 vcc, 0, v248
  s_cmp_ge_u32 s67, 131072
  s_cbranch_scc1 L_wfx
  s_cbranch_vccnz L_wf
L_wfx:
  ds_read_b64_tr_b16 v[200:201], v7 offset:0
  ds_read_b64_tr_b16 v[202:203], v7 offset:2048
  ds_read_b64_tr_b16 v[204:205], v7 offset:4096
  ds_read_b64_tr_b16 v[206:207], v7 offset:6144
  ds_read_b64_tr_b16 v[208:209], v7 offset:512
  ds_read_b64_tr_b16 v[210:211], v7 offset:2560
  ds_read_b64_tr_b16 v[212:213], v7 offset:4608
  ds_read_b64_tr_b16 v[214:215], v7 offset:6656
  ds_read_b64_tr_b16 v[216:217], v7 offset:1024
  ds_read_b64_tr_b16 v[218:219], v7 offset:3072
  ds_read_b64_tr_b16 v[220:221], v7 offset:5120
  ds_read_b64_tr_b16 v[222:223], v7 offset:7168
  ds_read_b64_tr_b16 v[224:225], v7 offset:1536
  ds_read_b64_tr_b16 v[226:227], v7 offset:3584
  ds_read_b64_tr_b16 v[228:229], v7 offset:5632
  ds_read_b64_tr_b16 v[230:231], v7 offset:7680
  s_waitcnt lgkmcnt(12)
  v_lshlrev_b32 v168, 16, v200
  v_and_b32 v169, 0xffff0000, v200
  v_lshlrev_b32 v170, 16, v201
  v_and_b32 v171, 0xffff0000, v201
  v_lshlrev_b32 v172, 16, v202
  v_and_b32 v173, 0xffff0000, v202
  v_lshlrev_b32 v174, 16, v203
  v_and_b32 v175, 0xffff0000, v203
  v_lshlrev_b32 v176, 16, v204
  v_and_b32 v177, 0xffff0000, v204
  v_lshlrev_b32 v178, 16, v205
  v_and_b32 v179, 0xffff0000, v205
  v_lshlrev_b32 v180, 16, v206
  v_and_b32 v181, 0xffff0000, v206
  v_lshlrev_b32 v182, 16, v207
  v_and_b32 v183, 0xffff0000, v207
  v_add_f32 v136, v168, v172
  v_add_f32 v137, v169, v173
  v_add_f32 v138, v170, v174
  v_add_f32 v139, v171, v175
  v_sub_f32 v168, v168, v172
  v_sub_f32 v169, v169, v173
  v_sub_f32 v170, v170, v174
  v_sub_f32 v171, v171, v175
  v_add_f32 v152, v176, v180
  v_add_f32 v153, v177, v181
  v_add_f32 v154, v178, v182
  v_add_f32 v155, v179, v183
  v_sub_f32 v176, v176, v180
  v_sub_f32 v177, v177, v181
  v_sub_f32 v178, v178, v182
  v_sub_f32 v179, v179, v183
  v_mul_f32 v172, v176, v68
  v_mul_f32 v173, v177, v69
  v_mul_f32 v174, v178, v74
  v_mul_f32 v175, v179, v75
  v_mul_f32 v68, v168, v68
  v_mul_f32 v69, v169, v69
  v_mul_f32 v74, v170, v74
  v_mul_f32 v75, v171, v75
  v_fmac_f32 v68, v176, v20
  v_fmac_f32 v69, v177, v21
  v_fmac_f32 v74, v178, v26
  v_fmac_f32 v75, v179, v27
  v_fma_f32 v20, v168, v20, -v172
  v_fma_f32 v21, v169, v21, -v173
  v_fma_f32 v26, v170, v26, -v174
  v_fma_f32 v27, v171, v27, -v175
  s_waitcnt lgkmcnt(0)
  s_mov_b32 m0, s17
  s_mov_b64 exec, 3
  buffer_load_dword off, s[36:39], s38 offset:880 lds
  s_mov_b64 exec, -1
  ds_read_b32 v3, v1 offset:848
  v_lshlrev_b32 v168, 16, v208
  v_and_b32 v169, 0xffff0000, v208
  v_lshlrev_b32 v170, 16, v209
  v_and_b32 v171, 0xffff0000, v209
  v_lshlrev_b32 v172, 16, v210
  v_and_b32 v173, 0xffff0000, v210
  v_lshlrev_b32 v174, 16, v211
  v_and_b32 v175, 0xffff0000, v211
  v_lshlrev_b32 v176, 16, v212
  v_and_b32 v177, 0xffff0000, v212
  v_lshlrev_b32 v178, 16, v213
  v_and_b32 v179, 0xffff0000, v213
  v_lshlrev_b32 v180, 16, v214
  v_and_b32 v181, 0xffff0000, v214
  v_lshlrev_b32 v182, 16, v215
  v_and_b32 v183, 0xffff0000, v215
  v_add_f32 v140, v168, v172
  v_add_f32 v141, v169, v173
  v_add_f32 v142, v170, v174
  v_add_f32 v143, v171, v175
  v_sub_f32 v168, v168, v172
  v_sub_f32 v169, v169, v173
  v_sub_f32 v170, v170, v174
  v_sub_f32 v171, v171, v175
  v_add_f32 v156, v176, v180
  v_add_f32 v157, v177, v181
  v_add_f32 v158, v178, v182
  v_add_f32 v159, v179, v183
  v_sub_f32 v176, v176, v180
  v_sub_f32 v177, v177, v181
  v_sub_f32 v178, v178, v182
  v_sub_f32 v179, v179, v183
  v_mul_f32 v172, v176, v80
  v_mul_f32 v173, v177, v81
  v_mul_f32 v174, v178, v86
  v_mul_f32 v175, v179, v87
  v_mul_f32 v80, v168, v80
  v_mul_f32 v81, v169, v81
  v_mul_f32 v86, v170, v86
  v_mul_f32 v87, v171, v87
  v_fmac_f32 v80, v176, v32
  v_fmac_f32 v81, v177, v33
  v_fmac_f32 v86, v178, v38
  v_fmac_f32 v87, v179, v39
  v_fma_f32 v32, v168, v32, -v172
  v_fma_f32 v33, v169, v33, -v173
  v_fma_f32 v38, v170, v38, -v174
  v_fma_f32 v39, v171, v39, -v175
  s_waitcnt lgkmcnt(0)
  v_cmp_ne_u32 vcc, 0, v3
s_nop 0
  s_or_b64 vcc, vcc, s[14:15]
  s_cbranch_scc1 snd24
  s_buffer_atomic_swap s68, s[36:39], s16 offset:0
  s_buffer_atomic_swap s68, s[36:39], s16 offset:16384
  s_buffer_atomic_swap s68, s[36:39], s16 offset:32768
  s_buffer_atomic_swap s68, s[36:39], s16 offset:49152
  s_mov_b64 s[14:15], -1
snd24:
  ds_read_b32 v3, v1 offset:848
  v_lshlrev_b32 v168, 16, v216
  v_and_b32 v169, 0xffff0000, v216
  v_lshlrev_b32 v170, 16, v217
  v_and_b32 v171, 0xffff0000, v217
  v_lshlrev_b32 v172, 16, v218
  v_and_b32 v173, 0xffff0000, v218
  v_lshlrev_b32 v174, 16, v219
  v_and_b32 v175, 0xffff0000, v219
  v_lshlrev_b32 v176, 16, v220
  v_and_b32 v177, 0xffff0000, v220
  v_lshlrev_b32 v178, 16, v221
  v_and_b32 v179, 0xffff0000, v221
  v_lshlrev_b32 v180, 16, v222
  v_and_b32 v181, 0xffff0000, v222
  v_lshlrev_b32 v182, 16, v223
  v_and_b32 v183, 0xffff0000, v223
  v_add_f32 v144, v168, v172
  v_add_f32 v145, v169, v173
  v_add_f32 v146, v170, v174
  v_add_f32 v147, v171, v175
  v_sub_f32 v168, v168, v172
  v_sub_f32 v169, v169, v173
  v_sub_f32 v170, v170, v174
  v_sub_f32 v171, v171, v175
  v_add_f32 v160, v176, v180
  v_add_f32 v161, v177, v181
  v_add_f32 v162, v178, v182
  v_add_f32 v163, v179, v183
  v_sub_f32 v176, v176, v180
  v_sub_f32 v177, v177, v181
  v_sub_f32 v178, v178, v182
  v_sub_f32 v179, v179, v183
  v_mul_f32 v172, v176, v92
  v_mul_f32 v173, v177, v93
  v_mul_f32 v174, v178, v98
  v_mul_f32 v175, v179, v99
  v_mul_f32 v92, v168, v92
  v_mul_f32 v93, v169, v93
  v_mul_f32 v98, v170, v98
  v_mul_f32 v99, v171, v99
  v_fmac_f32 v92, v176, v44
  v_fmac_f32 v93, v177, v45
  v_fmac_f32 v98, v178, v50
  v_fmac_f32 v99, v179, v51
  v_fma_f32 v44, v168, v44, -v172
  v_fma_f32 v45, v169, v45, -v173
  v_fma_f32 v50, v170, v50, -v174
  v_fma_f32 v51, v171, v51, -v175
  s_waitcnt lgkmcnt(0)
  v_cmp_ne_u32 vcc, 0, v3
s_nop 0
  s_or_b64 vcc, vcc, s[14:15]
  s_cbranch_scc1 snd26
  s_buffer_atomic_swap s68, s[36:39], s16 offset:0
  s_buffer_atomic_swap s68, s[36:39], s16 offset:16384
  s_buffer_atomic_swap s68, s[36:39], s16 offset:32768
  s_buffer_atomic_swap s68, s[36:39], s16 offset:49152
  s_mov_b64 s[14:15], -1
snd26:
  ds_read_b32 v3, v1 offset:848
  v_lshlrev_b32 v168, 16, v224
  v_and_b32 v169, 0xffff0000, v224
  v_lshlrev_b32 v170, 16, v225
  v_and_b32 v171, 0xffff0000, v225
  v_lshlrev_b32 v172, 16, v226
  v_and_b32 v173, 0xffff0000, v226
  v_lshlrev_b32 v174, 16, v227
  v_and_b32 v175, 0xffff0000, v227
  v_lshlrev_b32 v176, 16, v228
  v_and_b32 v177, 0xffff0000, v228
  v_lshlrev_b32 v178, 16, v229
  v_and_b32 v179, 0xffff0000, v229
  v_lshlrev_b32 v180, 16, v230
  v_and_b32 v181, 0xffff0000, v230
  v_lshlrev_b32 v182, 16, v231
  v_and_b32 v183, 0xffff0000, v231
  v_add_f32 v148, v168, v172
  v_add_f32 v149, v169, v173
  v_add_f32 v150, v170, v174
  v_add_f32 v151, v171, v175
  v_sub_f32 v168, v168, v172
  v_sub_f32 v169, v169, v173
  v_sub_f32 v170, v170, v174
  v_sub_f32 v171, v171, v175
  v_add_f32 v164, v176, v180
  v_add_f32 v165, v177, v181
  v_add_f32 v166, v178, v182
  v_add_f32 v167, v179, v183
  v_sub_f32 v176, v176, v180
  v_sub_f32 v177, v177, v181
  v_sub_f32 v178, v178, v182
  v_sub_f32 v179, v179, v183
  v_mul_f32 v172, v176, v104
  v_mul_f32 v173, v177, v105
  v_mul_f32 v174, v178, v110
  v_mul_f32 v175, v179, v111
  v_mul_f32 v104, v168, v104
  v_mul_f32 v105, v169, v105
  v_mul_f32 v110, v170, v110
  v_mul_f32 v111, v171, v111
  v_fmac_f32 v104, v176, v56
  v_fmac_f32 v105, v177, v57
  v_fmac_f32 v110, v178, v62
  v_fmac_f32 v111, v179, v63
  v_fma_f32 v56, v168, v56, -v172
  v_fma_f32 v57, v169, v57, -v173
  v_fma_f32 v62, v170, v62, -v174
  v_fma_f32 v63, v171, v63, -v175
  s_waitcnt lgkmcnt(0)
  v_cmp_ne_u32 vcc, 0, v3
s_nop 0
  s_or_b64 vcc, vcc, s[14:15]
  s_cbranch_scc1 snd28
  s_buffer_atomic_swap s68, s[36:39], s16 offset:0
  s_buffer_atomic_swap s68, s[36:39], s16 offset:16384
  s_buffer_atomic_swap s68, s[36:39], s16 offset:32768
  s_buffer_atomic_swap s68, s[36:39], s16 offset:49152
  s_mov_b64 s[14:15], -1
snd28:
  s_setprio 2
L_wt:
  ds_read_b32 v3, v1 offset:848
  s_waitcnt lgkmcnt(0)
  v_cmp_ne_u32 vcc, 0, v3
s_nop 0
  s_or_b64 vcc, vcc, s[14:15]
  s_cbranch_scc1 snd30
  s_buffer_atomic_swap s68, s[36:39], s16 offset:0
  s_buffer_atomic_swap s68, s[36:39], s16 offset:16384
  s_buffer_atomic_swap s68, s[36:39], s16 offset:32768
  s_buffer_atomic_swap s68, s[36:39], s16 offset:49152
  s_mov_b64 s[14:15], -1
snd30:
  s_add_u32 s67, s67, 1
  s_cmp_ge_u32 s67, 131072
  s_cbranch_scc1 L_wtx
  s_cmp_eq_u32 s14, 0
  s_cbranch_scc1 L_wt
L_wtx:
  s_mov_b32 m0, s18
L_mb0:
  s_buffer_load_dwordx8 s[28:35], s[36:39], s13 offset:0 glc
  s_buffer_load_dwordx8 s[40:47], s[36:39], s13 offset:128 glc
  s_buffer_load_dwordx8 s[48:55], s[36:39], s13 offset:256 glc
  s_buffer_load_dwordx8 s[20:27], s[36:39], s13 offset:384 glc
  s_add_u32 s67, s67, 8
  s_cmp_ge_u32 s67, 131072
  s_cbranch_scc1 L_mbx0
  s_waitcnt lgkmcnt(0)
  s_xor_b64 s[28:29], s[28:29], s[68:69]
  s_xor_b64 s[30:31], s[30:31], s[68:69]
  s_or_b64 s[28:29], s[28:29], s[30:31]
  s_xor_b64 s[32:33], s[32:33], s[68:69]
  s_or_b64 s[28:29], s[28:29], s[32:33]
  s_xor_b64 s[34:35], s[34:35], s[68:69]
  s_or_b64 s[28:29], s[28:29], s[34:35]
  s_xor_b64 s[40:41], s[40:41], s[68:69]
  s_or_b64 s[28:29], s[28:29], s[40:41]
  s_xor_b64 s[42:43], s[42:43], s[68:69]
  s_or_b64 s[28:29], s[28:29], s[42:43]
  s_xor_b64 s[44:45], s[44:45], s[68:69]
  s_or_b64 s[28:29], s[28:29], s[44:45]
  s_xor_b64 s[46:47], s[46:47], s[68:69]
  s_or_b64 s[28:29], s[28:29], s[46:47]
  s_xor_b64 s[48:49], s[48:49], s[68:69]
  s_or_b64 s[28:29], s[28:29], s[48:49]
  s_xor_b64 s[50:51], s[50:51], s[68:69]
  s_or_b64 s[28:29], s[28:29], s[50:51]
  s_xor_b64 s[52:53], s[52:53], s[68:69]
  s_or_b64 s[28:29], s[28:29], s[52:53]
  s_xor_b64 s[54:55], s[54:55], s[68:69]
  s_or_b64 s[28:29], s[28:29], s[54:55]
  s_xor_b64 s[20:21], s[20:21], s[68:69]
  s_or_b64 s[28:29], s[28:29], s[20:21]
  s_xor_b64 s[22:23], s[22:23], s[68:69]
  s_or_b64 s[28:29], s[28:29], s[22:23]
  s_xor_b64 s[24:25], s[24:25], s[68:69]
  s_or_b64 s[28:29], s[28:29], s[24:25]
  s_xor_b64 s[26:27], s[26:27], s[68:69]
  s_or_b64 s[28:29], s[28:29], s[26:27]
  s_cbranch_scc1 L_mb0
L_mbx0:
  buffer_load_dwordx4 v10, s[36:39], s10 offen offset:0 sc1 lds
  buffer_load_dwordx4 v10, s[36:39], s10 offen offset:1024 sc1 lds
  buffer_load_dwordx4 v10, s[36:39], s10 offen offset:2048 sc1 lds
  buffer_load_dwordx4 v10, s[36:39], s10 offen offset:3072 sc1 lds
  s_mov_b32 m0, s17
  s_mov_b64 exec, 3
  buffer_load_dword off, s[36:39], s38 offset:864 lds
  s_mov_b64 exec, -1
  s_waitcnt vmcnt(4)
  ds_read_b64_tr_b16 v[216:217], v11 offset:0
  ds_read_b64_tr_b16 v[218:219], v12 offset:0
  s_waitcnt vmcnt(3)
  ds_read_b64_tr_b16 v[220:221], v11 offset:1024
  ds_read_b64_tr_b16 v[222:223], v12 offset:1024
  s_waitcnt vmcnt(2)
  ds_read_b64_tr_b16 v[224:225], v11 offset:2048
  ds_read_b64_tr_b16 v[226:227], v12 offset:2048
  s_waitcnt vmcnt(1)
  ds_read_b64_tr_b16 v[228:229], v11 offset:3072
  ds_read_b64_tr_b16 v[230:231], v12 offset:3072
  ds_read_b32 v3, v1 offset:864
  v_add_u32 v11, s19, v11
  v_add_u32 v12, s19, v12
  s_waitcnt lgkmcnt(7)
  v_mfma_f32_32x32x16_bf16 v[168:183], v[114:117], v[216:219], 0
  v_mfma_f32_32x32x16_bf16 v[184:199], v[112:115], v[216:219], 0
  s_waitcnt lgkmcnt(0)
  v_cmp_ne_u32 vcc, 0, v3
  s_cbranch_vccnz slow_lc32
back_lc32:
  ds_read_b64_tr_b16 v[232:233], v11 offset:0
  ds_read_b64_tr_b16 v[234:235], v12 offset:0
  ds_read_b64_tr_b16 v[236:237], v11 offset:1024
  ds_read_b64_tr_b16 v[238:239], v12 offset:1024
  ds_read_b64_tr_b16 v[240:241], v11 offset:2048
  ds_read_b64_tr_b16 v[242:243], v12 offset:2048
  ds_read_b64_tr_b16 v[244:245], v11 offset:3072
  ds_read_b64_tr_b16 v[246:247], v12 offset:3072
  v_mfma_f32_32x32x16_bf16 v[168:183], v[120:123], v[220:223], v[168:183]
  v_mfma_f32_32x32x16_bf16 v[184:199], v[118:121], v[220:223], v[184:199]
  v_mfma_f32_32x32x16_bf16 v[168:183], v[126:129], v[224:227], v[168:183]
  v_mfma_f32_32x32x16_bf16 v[184:199], v[124:127], v[224:227], v[184:199]
  v_mfma_f32_32x32x16_bf16 v[168:183], v[132:135], v[228:231], v[168:183]
  v_mfma_f32_32x32x16_bf16 v[184:199], v[130:133], v[228:231], v[184:199]
  s_waitcnt lgkmcnt(6)
  v_mfma_f32_32x32x16_bf16 v[200:215], v[114:117], v[232:235], 0
  v_mfma_f32_32x32x16_bf16 v[216:231], v[112:115], v[232:235], 0
  v_mul_f32 v248, v184, v152
  v_mul_f32 v249, v185, v153
  v_mul_f32 v250, v186, v154
  v_mul_f32 v251, v187, v155
  v_mul_f32 v152, v168, v152
  v_mul_f32 v153, v169, v153
  s_waitcnt lgkmcnt(4)
  v_mfma_f32_32x32x16_bf16 v[200:215], v[120:123], v[236:239], v[200:215]
  v_mul_f32 v154, v170, v154
  v_mul_f32 v155, v171, v155
  v_fmac_f32 v152, v184, v136
  v_fmac_f32 v153, v185, v137
  v_fmac_f32 v154, v186, v138
  v_fmac_f32 v155, v187, v139
  v_mfma_f32_32x32x16_bf16 v[216:231], v[118:121], v[236:239], v[216:231]
  v_fma_f32 v136, v168, v136, -v248
  v_fma_f32 v137, v169, v137, -v249
  v_fma_f32 v138, v170, v138, -v250
  v_fma_f32 v139, v171, v139, -v251
  v_mul_f32 v248, v188, v156
  v_mul_f32 v249, v189, v157
  s_waitcnt lgkmcnt(2)
  v_mfma_f32_32x32x16_bf16 v[200:215], v[126:129], v[240:243], v[200:215]
  v_mul_f32 v250, v190, v158
  v_mul_f32 v251, v191, v159
  v_mul_f32 v156, v172, v156
  v_mul_f32 v157, v173, v157
  v_mul_f32 v158, v174, v158
  v_mul_f32 v159, v175, v159
  v_mfma_f32_32x32x16_bf16 v[216:231], v[124:127], v[240:243], v[216:231]
  v_fmac_f32 v156, v188, v140
  v_fmac_f32 v157, v189, v141
  v_fmac_f32 v158, v190, v142
  v_fmac_f32 v159, v191, v143
  v_fma_f32 v140, v172, v140, -v248
  v_fma_f32 v141, v173, v141, -v249
  s_waitcnt lgkmcnt(0)
  v_mfma_f32_32x32x16_bf16 v[200:215], v[132:135], v[244:247], v[200:215]
  v_fma_f32 v142, v174, v142, -v250
  v_fma_f32 v143, v175, v143, -v251
  v_mul_f32 v248, v192, v160
  v_mul_f32 v249, v193, v161
  v_mul_f32 v250, v194, v162
  v_mul_f32 v251, v195, v163
  v_mfma_f32_32x32x16_bf16 v[216:231], v[130:133], v[244:247], v[216:231]
  v_mul_f32 v160, v176, v160
  v_mul_f32 v161, v177, v161
  v_mul_f32 v162, v178, v162
  v_mul_f32 v163, v179, v163
  v_fmac_f32 v160, v192, v144
  v_fmac_f32 v161, v193, v145
  v_fmac_f32 v162, v194, v146
  v_fmac_f32 v163, v195, v147
  v_fma_f32 v144, v176, v144, -v248
  v_fma_f32 v145, v177, v145, -v249
  v_fma_f32 v146, v178, v146, -v250
  v_fma_f32 v147, v179, v147, -v251
  v_mul_f32 v248, v196, v164
  v_mul_f32 v249, v197, v165
  v_mul_f32 v250, v198, v166
  v_mul_f32 v251, v199, v167
  v_mul_f32 v164, v180, v164
  v_mul_f32 v165, v181, v165
  v_mul_f32 v166, v182, v166
  v_mul_f32 v167, v183, v167
  v_fmac_f32 v164, v196, v148
  v_fmac_f32 v165, v197, v149
  v_fmac_f32 v166, v198, v150
  v_fmac_f32 v167, v199, v151
  v_fma_f32 v148, v180, v148, -v248
  v_fma_f32 v149, v181, v149, -v249
  v_fma_f32 v150, v182, v150, -v250
  v_fma_f32 v151, v183, v151, -v251
  v_fmac_f32 v152, v200, v68
  v_fmac_f32 v153, v201, v69
  v_fmac_f32 v154, v202, v74
  v_fmac_f32 v155, v203, v75
  v_fmac_f32 v136, v200, v20
  v_fmac_f32 v137, v201, v21
  v_fmac_f32 v138, v202, v26
  v_fmac_f32 v139, v203, v27
  v_fmac_f32 v152, v216, v20
  v_fmac_f32 v153, v217, v21
  v_fmac_f32 v154, v218, v26
  v_fmac_f32 v155, v219, v27
  v_fma_f32 v136, -v216, v68, v136
  v_fma_f32 v137, -v217, v69, v137
  v_fma_f32 v138, -v218, v74, v138
  v_fma_f32 v139, -v219, v75, v139
  v_cvt_pk_bf16_f32 v232, v152, v153
  v_cvt_pk_bf16_f32 v233, v154, v155
  v_cvt_pk_bf16_f32 v234, v136, v137
  v_cvt_pk_bf16_f32 v235, v138, v139
  v_xor_b32 v20, 0x80008000, v16
  v_xor_b32 v21, 0x80008000, v17
  v_mfma_f32_32x32x16_bf16 v[168:183], v[232:235], v[112:115], 0
  v_fmac_f32 v156, v204, v80
  v_fmac_f32 v157, v205, v81
  v_fmac_f32 v158, v206, v86
  v_fmac_f32 v159, v207, v87
  v_fmac_f32 v140, v204, v32
  v_fmac_f32 v141, v205, v33
  v_fmac_f32 v142, v206, v38
  v_fmac_f32 v143, v207, v39
  v_mfma_f32_32x32x16_bf16 v[184:199], v[232:235], v[114:117], 0
  v_fmac_f32 v156, v220, v32
  v_fmac_f32 v157, v221, v33
  v_fmac_f32 v158, v222, v38
  v_fmac_f32 v159, v223, v39
  v_fma_f32 v140, -v220, v80, v140
  v_fma_f32 v141, -v221, v81, v141
  v_fma_f32 v142, -v222, v86, v142
  v_fma_f32 v143, -v223, v87, v143
  v_cvt_pk_bf16_f32 v236, v156, v157
  v_cvt_pk_bf16_f32 v237, v158, v159
  v_cvt_pk_bf16_f32 v238, v140, v141
  v_cvt_pk_bf16_f32 v239, v142, v143
  v_xor_b32 v32, 0x80008000, v28
  v_xor_b32 v33, 0x80008000, v29
  v_mfma_f32_32x32x16_bf16 v[168:183], v[236:239], v[118:121], v[168:183]
  v_fmac_f32 v160, v208, v92
  v_fmac_f32 v161, v209, v93
  v_fmac_f32 v162, v210, v98
  v_fmac_f32 v163, v211, v99
  v_fmac_f32 v144, v208, v44
  v_fmac_f32 v145, v209, v45
  v_fmac_f32 v146, v210, v50
  v_fmac_f32 v147, v211, v51
  v_mfma_f32_32x32x16_bf16 v[184:199], v[236:239], v[120:123], v[184:199]
  v_fmac_f32 v160, v224, v44
  v_fmac_f32 v161, v225, v45
  v_fmac_f32 v162, v226, v50
  v_fmac_f32 v163, v227, v51
  v_fma_f32 v144, -v224, v92, v144
  v_fma_f32 v145, -v225, v93, v145
  v_fma_f32 v146, -v226, v98, v146
  v_fma_f32 v147, -v227, v99, v147
  v_cvt_pk_bf16_f32 v240, v160, v161
  v_cvt_pk_bf16_f32 v241, v162, v163
  v_cvt_pk_bf16_f32 v242, v144, v145
  v_cvt_pk_bf16_f32 v243, v146, v147
  v_xor_b32 v44, 0x80008000, v40
  v_xor_b32 v45, 0x80008000, v41
  v_mfma_f32_32x32x16_bf16 v[168:183], v[240:243], v[124:127], v[168:183]
  v_fmac_f32 v164, v212, v104
  v_fmac_f32 v165, v213, v105
  v_fmac_f32 v166, v214, v110
  v_fmac_f32 v167, v215, v111
  v_fmac_f32 v148, v212, v56
  v_fmac_f32 v149, v213, v57
  v_fmac_f32 v150, v214, v62
  v_fmac_f32 v151, v215, v63
  v_mfma_f32_32x32x16_bf16 v[184:199], v[240:243], v[126:129], v[184:199]
  v_fmac_f32 v164, v228, v56
  v_fmac_f32 v165, v229, v57
  v_fmac_f32 v166, v230, v62
  v_fmac_f32 v167, v231, v63
  v_fma_f32 v148, -v228, v104, v148
  v_fma_f32 v149, -v229, v105, v149
  v_fma_f32 v150, -v230, v110, v150
  v_fma_f32 v151, -v231, v111, v151
  v_cvt_pk_bf16_f32 v244, v164, v165
  v_cvt_pk_bf16_f32 v245, v166, v167
  v_cvt_pk_bf16_f32 v246, v148, v149
  v_cvt_pk_bf16_f32 v247, v150, v151
  v_xor_b32 v56, 0x80008000, v52
  v_xor_b32 v57, 0x80008000, v53
  v_mfma_f32_32x32x16_bf16 v[168:183], v[244:247], v[130:133], v[168:183]
  v_mfma_f32_32x32x16_bf16 v[184:199], v[244:247], v[132:135], v[184:199]
  v_xor_b32 v26, 0x80008000, v22
  v_xor_b32 v27, 0x80008000, v23
  v_xor_b32 v38, 0x80008000, v34
  v_xor_b32 v39, 0x80008000, v35
  v_xor_b32 v50, 0x80008000, v46
  v_xor_b32 v51, 0x80008000, v47
  v_xor_b32 v62, 0x80008000, v58
  v_xor_b32 v63, 0x80008000, v59
  v_xor_b32 v68, 0x80008000, v64
  v_xor_b32 v69, 0x80008000, v65
  s_add_u32 s20, s11, 65792
  s_add_u32 s21, s11, 131584
  s_add_u32 s22, s11, 197376
  v_cvt_pk_bf16_f32 v200, v168, v170
  v_cvt_pk_bf16_f32 v201, v172, v174
  v_cvt_pk_bf16_f32 v204, v169, v171
  v_cvt_pk_bf16_f32 v205, v173, v175
  v_cvt_pk_bf16_f32 v208, v176, v178
  v_cvt_pk_bf16_f32 v209, v180, v182
  v_cvt_pk_bf16_f32 v212, v177, v179
  v_cvt_pk_bf16_f32 v213, v181, v183
  v_cvt_pk_bf16_f32 v202, v184, v186
  v_cvt_pk_bf16_f32 v203, v188, v190
  v_cvt_pk_bf16_f32 v206, v185, v187
  v_cvt_pk_bf16_f32 v207, v189, v191
  v_cvt_pk_bf16_f32 v210, v192, v194
  v_cvt_pk_bf16_f32 v211, v196, v198
  v_cvt_pk_bf16_f32 v214, v193, v195
  v_cvt_pk_bf16_f32 v215, v197, v199
  s_mov_b32 vcc_lo, 0x55555555
  s_mov_b32 vcc_hi, 0x55555555
  v_cndmask_b32_dpp v216, v204, v200, vcc quad_perm:[1,0,3,2] row_mask:0xf bank_mask:0xf
  v_cndmask_b32_dpp v217, v205, v201, vcc quad_perm:[1,0,3,2] row_mask:0xf bank_mask:0xf
  v_cndmask_b32_dpp v218, v206, v202, vcc quad_perm:[1,0,3,2] row_mask:0xf bank_mask:0xf
  v_cndmask_b32_dpp v219, v207, v203, vcc quad_perm:[1,0,3,2] row_mask:0xf bank_mask:0xf
  v_cndmask_b32_dpp v220, v212, v208, vcc quad_perm:[1,0,3,2] row_mask:0xf bank_mask:0xf
  v_cndmask_b32_dpp v221, v213, v209, vcc quad_perm:[1,0,3,2] row_mask:0xf bank_mask:0xf
  v_cndmask_b32_dpp v222, v214, v210, vcc quad_perm:[1,0,3,2] row_mask:0xf bank_mask:0xf
  v_cndmask_b32_dpp v223, v215, v211, vcc quad_perm:[1,0,3,2] row_mask:0xf bank_mask:0xf
  s_not_b64 vcc, vcc
  v_cndmask_b32_dpp v204, v200, v204, vcc quad_perm:[1,0,3,2] row_mask:0xf bank_mask:0xf
  v_cndmask_b32_dpp v205, v201, v205, vcc quad_perm:[1,0,3,2] row_mask:0xf bank_mask:0xf
  v_cndmask_b32_dpp v206, v202, v206, vcc quad_perm:[1,0,3,2] row_mask:0xf bank_mask:0xf
  v_cndmask_b32_dpp v207, v203, v207, vcc quad_perm:[1,0,3,2] row_mask:0xf bank_mask:0xf
  v_cndmask_b32_dpp v212, v208, v212, vcc quad_perm:[1,0,3,2] row_mask:0xf bank_mask:0xf
  v_cndmask_b32_dpp v213, v209, v213, vcc quad_perm:[1,0,3,2] row_mask:0xf bank_mask:0xf
  v_cndmask_b32_dpp v214, v210, v214, vcc quad_perm:[1,0,3,2] row_mask:0xf bank_mask:0xf
  v_cndmask_b32_dpp v215, v211, v215, vcc quad_perm:[1,0,3,2] row_mask:0xf bank_mask:0xf
  s_mov_b32 vcc_lo, 0x33333333
  s_mov_b32 vcc_hi, 0x33333333
  v_cndmask_b32_dpp v200, v220, v216, vcc quad_perm:[2,3,0,1] row_mask:0xf bank_mask:0xf
  v_cndmask_b32_dpp v201, v221, v217, vcc quad_perm:[2,3,0,1] row_mask:0xf bank_mask:0xf
  v_cndmask_b32_dpp v202, v222, v218, vcc quad_perm:[2,3,0,1] row_mask:0xf bank_mask:0xf
  v_cndmask_b32_dpp v203, v223, v219, vcc quad_perm:[2,3,0,1] row_mask:0xf bank_mask:0xf
  v_cndmask_b32_dpp v208, v212, v204, vcc quad_perm:[2,3,0,1] row_mask:0xf bank_mask:0xf
  v_cndmask_b32_dpp v209, v213, v205, vcc quad_perm:[2,3,0,1] row_mask:0xf bank_mask:0xf
  v_cndmask_b32_dpp v210, v214, v206, vcc quad_perm:[2,3,0,1] row_mask:0xf bank_mask:0xf
  v_cndmask_b32_dpp v211, v215, v207, vcc quad_perm:[2,3,0,1] row_mask:0xf bank_mask:0xf
  s_not_b64 vcc, vcc
  buffer_store_dwordx4 v[200:203], v13, s[36:39], s11 offen sc1
  buffer_store_dwordx4 v[208:211], v13, s[36:39], s20 offen sc1
  v_cndmask_b32_dpp v220, v216, v220, vcc quad_perm:[2,3,0,1] row_mask:0xf bank_mask:0xf
  v_cndmask_b32_dpp v221, v217, v221, vcc quad_perm:[2,3,0,1] row_mask:0xf bank_mask:0xf
  v_cndmask_b32_dpp v222, v218, v222, vcc quad_perm:[2,3,0,1] row_mask:0xf bank_mask:0xf
  v_cndmask_b32_dpp v223, v219, v223, vcc quad_perm:[2,3,0,1] row_mask:0xf bank_mask:0xf
  v_cndmask_b32_dpp v212, v204, v212, vcc quad_perm:[2,3,0,1] row_mask:0xf bank_mask:0xf
  v_cndmask_b32_dpp v213, v205, v213, vcc quad_perm:[2,3,0,1] row_mask:0xf bank_mask:0xf
  v_cndmask_b32_dpp v214, v206, v214, vcc quad_perm:[2,3,0,1] row_mask:0xf bank_mask:0xf
  v_cndmask_b32_dpp v215, v207, v215, vcc quad_perm:[2,3,0,1] row_mask:0xf bank_mask:0xf
  buffer_store_dwordx4 v[220:223], v13, s[36:39], s21 offen sc1
  buffer_store_dwordx4 v[212:215], v13, s[36:39], s22 offen sc1
  s_setprio 0
  v_xor_b32 v74, 0x80008000, v70
  v_xor_b32 v75, 0x80008000, v71
  v_xor_b32 v80, 0x80008000, v76
  v_xor_b32 v81, 0x80008000, v77
  v_xor_b32 v86, 0x80008000, v82
  v_xor_b32 v87, 0x80008000, v83
  v_xor_b32 v92, 0x80008000, v88
  v_xor_b32 v93, 0x80008000, v89
  v_xor_b32 v98, 0x80008000, v94
  v_xor_b32 v99, 0x80008000, v95
  v_xor_b32 v104, 0x80008000, v100
  v_xor_b32 v105, 0x80008000, v101
  v_xor_b32 v110, 0x80008000, v106
  v_xor_b32 v111, 0x80008000, v107
  s_mov_b32 exec_hi, 0
  s_waitcnt vmcnt(0)
  buffer_atomic_add v15, v14, s[36:39], s12 offen sc1
  s_mov_b32 exec_hi, -1
  ds_read_b32 v3, v1 offset:48
  s_waitcnt lgkmcnt(0)
  v_cmp_gt_u32 vcc, 2, v3
  s_cbranch_vccnz slow_lc34
back_lc34:
  s_branch L_p3
slow_lc32:
  ds_read_b32 v3, v1 offset:864
  s_add_u32 s67, s67, 1
  s_waitcnt lgkmcnt(0)
  v_cmp_ne_u32 vcc, 0, v3
  s_cmp_ge_u32 s67, 131072
  s_cbranch_scc1 back_lc32
  s_cbranch_vccnz slow_lc32
  s_branch back_lc32
slow_lc34:
  ds_read_b32 v3, v1 offset:48
  s_add_u32 s67, s67, 1
  s_waitcnt lgkmcnt(0)
  v_cmp_gt_u32 vcc, 2, v3
  s_cmp_ge_u32 s67, 131072
  s_cbranch_scc1 back_lc34
  s_cbranch_vccnz slow_lc34
  s_branch back_lc34
L_F23:
  v_lshrrev_b32 v138, 3, v0
  v_mul_u32_u24 v132, 3584, v138
  v_lshlrev_b32 v133, 2, v0
  v_xor_b32 v133, v133, v2
  v_and_b32 v133, 64, v133
  v_and_or_b32 v133, v2, 48, v133
  s_cmp_eq_u32 s6, 2
  s_cselect_b32 s3, 0x80, 0
  s_lshr_b32 s11, s3, 1
  s_or_b32 s11, s11, 0x80
  v_add3_u32 v128, v132, v133, s3
  v_add_u32 v129, 27648, v128
  v_add_u32 v130, 55296, v128
  v_add_u32 v131, 82944, v128
  v_xor_b32 v132, s11, v128
  v_xor_b32 v133, s11, v129
  v_xor_b32 v134, s11, v130
  v_xor_b32 v135, s11, v131
  s_mul_i32 s12, s64, 7
  s_add_u32 s12, s12, 1
  s_lshr_b32 s12, s12, 2
  s_mul_i32 s3, s8, 896
  s_add_u32 s12, s12, s3
  s_lshl_b32 s12, s12, 7
  s_lshl_b32 s10, s8, 12
  s_lshl3_add_u32 s20, s8, 159744
  v_lshrrev_b32 v138, 2, v0
  v_mul_u32_u24 v138, 16448, v138
  v_and_or_b32 v138, v2, 48, v138
  s_mul_i32 s13, s9, 514
  s_lshl_b32 s3, s66, 6
  s_add_u32 s13, s13, s3
  s_and_b32 s3, s63, 7
  s_lshl3_add_u32 s3, s5, s3
  s_mul_i32 s14, s3, 448
  s_lshl2_add_u32 s14, s8, s14
  s_add_u32 s14, s14, s6
  s_lshl_b32 s14, s14, 7
  v_min_u32 v139, 55, v0
  v_lshlrev_b32 v139, 10, v139
  s_cmp_eq_u32 s8, 0
  s_mov_b32 s26, 0x101000
  s_mov_b32 s27, 0x20000
  s_waitcnt lgkmcnt(0)
  s_cselect_b64 s[24:25], s[44:45], s[48:49]
  s_buffer_load_dword s68, s[36:39], 0
  s_lshl2_add_u32 s3, s6, s4
  s_lshl_b32 s3, s3, 4
  v_xor_b32 v8, s3, v6
  v_cvt_f32_u32 v8, v8
  v_mul_f32 v8, 0x3b800000, v8
  v_lshl_add_u32 v7, v5, 2, s8
  v_cmp_eq_u32 vcc, 0, v7
  v_cvt_f32_u32 v7, v7
  v_mul_f32 v7, 0.5, v7
  v_cndmask_b32 v9, 1.0, 0.5, vcc
  v_mul_f32 v7, v7, v8
  v_mul_f32 v10, 0x40400000, v8
  v_cos_f32 v248, v7
  v_sin_f32 v252, v7
  v_add_f32 v7, v7, v8
  v_cos_f32 v249, v7
  v_sin_f32 v253, v7
  v_add_f32 v7, v7, v10
  v_mul_f32 v248, v248, v9
  v_cos_f32 v250, v7
  v_sin_f32 v254, v7
  v_add_f32 v7, v7, v8
  v_cos_f32 v251, v7
  v_sin_f32 v255, v7
  v_add_f32 v7, v7, v10
  v_cvt_pk_bf16_f32 v18, v248, v249
  v_cvt_pk_bf16_f32 v16, v252, v253
  v_cvt_pk_bf16_f32 v19, v250, v251
  v_cvt_pk_bf16_f32 v17, v254, v255
  v_xor_b32 v20, 0x80008000, v16
  v_xor_b32 v21, 0x80008000, v17
  v_cos_f32 v248, v7
  v_sin_f32 v252, v7
  v_add_f32 v7, v7, v8
  v_cos_f32 v249, v7
  v_sin_f32 v253, v7
  v_add_f32 v7, v7, v10
  v_cos_f32 v250, v7
  v_sin_f32 v254, v7
  v_add_f32 v7, v7, v8
  v_cos_f32 v251, v7
  v_sin_f32 v255, v7
  v_add_f32 v7, v7, v10
  v_cvt_pk_bf16_f32 v24, v248, v249
  v_cvt_pk_bf16_f32 v22, v252, v253
  v_cvt_pk_bf16_f32 v25, v250, v251
  v_cvt_pk_bf16_f32 v23, v254, v255
  v_xor_b32 v26, 0x80008000, v22
  v_xor_b32 v27, 0x80008000, v23
  v_cos_f32 v248, v7
  v_sin_f32 v252, v7
  v_add_f32 v7, v7, v8
  v_cos_f32 v249, v7
  v_sin_f32 v253, v7
  v_add_f32 v7, v7, v10
  v_cos_f32 v250, v7
  v_sin_f32 v254, v7
  v_add_f32 v7, v7, v8
  v_cos_f32 v251, v7
  v_sin_f32 v255, v7
  v_add_f32 v7, v7, v10
  v_cvt_pk_bf16_f32 v30, v248, v249
  v_cvt_pk_bf16_f32 v28, v252, v253
  v_cvt_pk_bf16_f32 v31, v250, v251
  v_cvt_pk_bf16_f32 v29, v254, v255
  v_xor_b32 v32, 0x80008000, v28
  v_xor_b32 v33, 0x80008000, v29
  v_cos_f32 v248, v7
  v_sin_f32 v252, v7
  v_add_f32 v7, v7, v8
  v_cos_f32 v249, v7
  v_sin_f32 v253, v7
  v_add_f32 v7, v7, v10
  v_cos_f32 v250, v7
  v_sin_f32 v254, v7
  v_add_f32 v7, v7, v8
  v_cos_f32 v251, v7
  v_sin_f32 v255, v7
  v_add_f32 v7, v7, v10
  v_cvt_pk_bf16_f32 v36, v248, v249
  v_cvt_pk_bf16_f32 v34, v252, v253
  v_cvt_pk_bf16_f32 v37, v250, v251
  v_cvt_pk_bf16_f32 v35, v254, v255
  v_xor_b32 v38, 0x80008000, v34
  v_xor_b32 v39, 0x80008000, v35
  v_cos_f32 v248, v7
  v_sin_f32 v252, v7
  v_add_f32 v7, v7, v8
  v_cos_f32 v249, v7
  v_sin_f32 v253, v7
  v_add_f32 v7, v7, v10
  v_cos_f32 v250, v7
  v_sin_f32 v254, v7
  v_add_f32 v7, v7, v8
  v_cos_f32 v251, v7
  v_sin_f32 v255, v7
  v_add_f32 v7, v7, v10
  v_cvt_pk_bf16_f32 v42, v248, v249
  v_cvt_pk_bf16_f32 v40, v252, v253
  v_cvt_pk_bf16_f32 v43, v250, v251
  v_cvt_pk_bf16_f32 v41, v254, v255
  v_xor_b32 v44, 0x80008000, v40
  v_xor_b32 v45, 0x80008000, v41
  s_barrier
  v_cos_f32 v248, v7
  v_sin_f32 v252, v7
  v_add_f32 v7, v7, v8
  v_cos_f32 v249, v7
  v_sin_f32 v253, v7
  v_add_f32 v7, v7, v10
  v_cos_f32 v250, v7
  v_sin_f32 v254, v7
  v_add_f32 v7, v7, v8
  v_cos_f32 v251, v7
  v_sin_f32 v255, v7
  v_add_f32 v7, v7, v10
  v_cvt_pk_bf16_f32 v48, v248, v249
  v_cvt_pk_bf16_f32 v46, v252, v253
  v_cvt_pk_bf16_f32 v49, v250, v251
  v_cvt_pk_bf16_f32 v47, v254, v255
  v_xor_b32 v50, 0x80008000, v46
  v_xor_b32 v51, 0x80008000, v47
  v_cos_f32 v248, v7
  v_sin_f32 v252, v7
  v_add_f32 v7, v7, v8
  v_cos_f32 v249, v7
  v_sin_f32 v253, v7
  v_add_f32 v7, v7, v10
  v_cos_f32 v250, v7
  v_sin_f32 v254, v7
  v_add_f32 v7, v7, v8
  v_cos_f32 v251, v7
  v_sin_f32 v255, v7
  v_add_f32 v7, v7, v10
  v_cvt_pk_bf16_f32 v54, v248, v249
  v_cvt_pk_bf16_f32 v52, v252, v253
  v_cvt_pk_bf16_f32 v55, v250, v251
  v_cvt_pk_bf16_f32 v53, v254, v255
  v_xor_b32 v56, 0x80008000, v52
  v_xor_b32 v57, 0x80008000, v53
  v_cos_f32 v248, v7
  v_sin_f32 v252, v7
  v_add_f32 v7, v7, v8
  v_cos_f32 v249, v7
  v_sin_f32 v253, v7
  v_add_f32 v7, v7, v10
  v_cos_f32 v250, v7
  v_sin_f32 v254, v7
  v_add_f32 v7, v7, v8
  v_cos_f32 v251, v7
  v_sin_f32 v255, v7
  v_add_f32 v7, v7, v10
  v_cvt_pk_bf16_f32 v60, v248, v249
  v_cvt_pk_bf16_f32 v58, v252, v253
  v_cvt_pk_bf16_f32 v61, v250, v251
  v_cvt_pk_bf16_f32 v59, v254, v255
  v_xor_b32 v62, 0x80008000, v58
  v_xor_b32 v63, 0x80008000, v59
  v_cos_f32 v248, v7
  v_sin_f32 v252, v7
  v_add_f32 v7, v7, v8
  v_cos_f32 v249, v7
  v_sin_f32 v253, v7
  v_add_f32 v7, v7, v10
  v_cos_f32 v250, v7
  v_sin_f32 v254, v7
  v_add_f32 v7, v7, v8
  v_cos_f32 v251, v7
  v_sin_f32 v255, v7
  v_add_f32 v7, v7, v10
  v_cvt_pk_bf16_f32 v66, v248, v249
  v_cvt_pk_bf16_f32 v64, v252, v253
  v_cvt_pk_bf16_f32 v67, v250, v251
  v_cvt_pk_bf16_f32 v65, v254, v255
  v_xor_b32 v68, 0x80008000, v64
  v_xor_b32 v69, 0x80008000, v65
  v_cos_f32 v248, v7
  v_sin_f32 v252, v7
  v_add_f32 v7, v7, v8
  v_cos_f32 v249, v7
  v_sin_f32 v253, v7
  v_add_f32 v7, v7, v10
  v_cos_f32 v250, v7
  v_sin_f32 v254, v7
  v_add_f32 v7, v7, v8
  v_cos_f32 v251, v7
  v_sin_f32 v255, v7
  v_add_f32 v7, v7, v10
  v_cvt_pk_bf16_f32 v72, v248, v249
  v_cvt_pk_bf16_f32 v70, v252, v253
  v_cvt_pk_bf16_f32 v73, v250, v251
  v_cvt_pk_bf16_f32 v71, v254, v255
  v_xor_b32 v74, 0x80008000, v70
  v_xor_b32 v75, 0x80008000, v71
  v_cos_f32 v248, v7
  v_sin_f32 v252, v7
  v_add_f32 v7, v7, v8
  v_cos_f32 v249, v7
  v_sin_f32 v253, v7
  v_add_f32 v7, v7, v10
  v_cos_f32 v250, v7
  v_sin_f32 v254, v7
  v_add_f32 v7, v7, v8
  v_cos_f32 v251, v7
  v_sin_f32 v255, v7
  v_add_f32 v7, v7, v10
  v_cvt_pk_bf16_f32 v78, v248, v249
  v_cvt_pk_bf16_f32 v76, v252, v253
  v_cvt_pk_bf16_f32 v79, v250, v251
  v_cvt_pk_bf16_f32 v77, v254, v255
  v_xor_b32 v80, 0x80008000, v76
  v_xor_b32 v81, 0x80008000, v77
  v_cos_f32 v248, v7
  v_sin_f32 v252, v7
  v_add_f32 v7, v7, v8
  v_cos_f32 v249, v7
  v_sin_f32 v253, v7
  v_add_f32 v7, v7, v10
  v_cos_f32 v250, v7
  v_sin_f32 v254, v7
  v_add_f32 v7, v7, v8
  v_cos_f32 v251, v7
  v_sin_f32 v255, v7
  v_add_f32 v7, v7, v10
  v_cvt_pk_bf16_f32 v84, v248, v249
  v_cvt_pk_bf16_f32 v82, v252, v253
  v_cvt_pk_bf16_f32 v85, v250, v251
  v_cvt_pk_bf16_f32 v83, v254, v255
  v_xor_b32 v86, 0x80008000, v82
  v_xor_b32 v87, 0x80008000, v83
  v_cos_f32 v248, v7
  v_sin_f32 v252, v7
  v_add_f32 v7, v7, v8
  v_cos_f32 v249, v7
  v_sin_f32 v253, v7
  v_add_f32 v7, v7, v10
  v_cos_f32 v250, v7
  v_sin_f32 v254, v7
  v_add_f32 v7, v7, v8
  v_cos_f32 v251, v7
  v_sin_f32 v255, v7
  v_add_f32 v7, v7, v10
  v_cvt_pk_bf16_f32 v90, v248, v249
  v_cvt_pk_bf16_f32 v88, v252, v253
  v_cvt_pk_bf16_f32 v91, v250, v251
  v_cvt_pk_bf16_f32 v89, v254, v255
  v_xor_b32 v92, 0x80008000, v88
  v_xor_b32 v93, 0x80008000, v89
  v_cos_f32 v248, v7
  v_sin_f32 v252, v7
  v_add_f32 v7, v7, v8
  v_cos_f32 v249, v7
  v_sin_f32 v253, v7
  v_add_f32 v7, v7, v10
  v_cos_f32 v250, v7
  v_sin_f32 v254, v7
  v_add_f32 v7, v7, v8
  v_cos_f32 v251, v7
  v_sin_f32 v255, v7
  v_add_f32 v7, v7, v10
  v_cvt_pk_bf16_f32 v96, v248, v249
  v_cvt_pk_bf16_f32 v94, v252, v253
  v_cvt_pk_bf16_f32 v97, v250, v251
  v_cvt_pk_bf16_f32 v95, v254, v255
  v_xor_b32 v98, 0x80008000, v94
  v_xor_b32 v99, 0x80008000, v95
  v_cos_f32 v248, v7
  v_sin_f32 v252, v7
  v_add_f32 v7, v7, v8
  v_cos_f32 v249, v7
  v_sin_f32 v253, v7
  v_add_f32 v7, v7, v10
  v_cos_f32 v250, v7
  v_sin_f32 v254, v7
  v_add_f32 v7, v7, v8
  v_cos_f32 v251, v7
  v_sin_f32 v255, v7
  v_add_f32 v7, v7, v10
  v_cvt_pk_bf16_f32 v102, v248, v249
  v_cvt_pk_bf16_f32 v100, v252, v253
  v_cvt_pk_bf16_f32 v103, v250, v251
  v_cvt_pk_bf16_f32 v101, v254, v255
  v_xor_b32 v104, 0x80008000, v100
  v_xor_b32 v105, 0x80008000, v101
  v_cos_f32 v248, v7
  v_sin_f32 v252, v7
  v_add_f32 v7, v7, v8
  v_cos_f32 v249, v7
  v_sin_f32 v253, v7
  v_add_f32 v7, v7, v10
  v_cos_f32 v250, v7
  v_sin_f32 v254, v7
  v_add_f32 v7, v7, v8
  v_cos_f32 v251, v7
  v_sin_f32 v255, v7
  v_add_f32 v7, v7, v10
  v_cvt_pk_bf16_f32 v108, v248, v249
  v_cvt_pk_bf16_f32 v106, v252, v253
  v_cvt_pk_bf16_f32 v109, v250, v251
  v_cvt_pk_bf16_f32 v107, v254, v255
  v_xor_b32 v110, 0x80008000, v106
  v_xor_b32 v111, 0x80008000, v107
  ds_read_b32 v3, v1 offset:832
  s_waitcnt lgkmcnt(0)
  v_cmp_ne_u32 vcc, 0, v3
  s_cbranch_vccnz slow_lc36
back_lc36:
  s_xor_b32 s3, s65, 0
  s_mul_i32 s3, s3, 229376
  s_add_u32 m0, s10, 0
  s_add_u32 s11, s3, s12
  buffer_load_dwordx4 v128, s[32:35], s11 offen offset:0 lds
  buffer_load_dwordx4 v129, s[32:35], s11 offen offset:1024 lds
  buffer_load_dwordx4 v130, s[32:35], s11 offen offset:2048 lds
  buffer_load_dwordx4 v131, s[32:35], s11 offen offset:3072 lds
  s_mov_b32 m0, s20
  s_mov_b64 exec, 3
  buffer_load_dword off, s[32:35], s34 offset:256 lds
  s_mov_b64 exec, -1
  s_xor_b32 s3, s65, 0
  s_mul_i32 s3, s3, 229376
  s_add_u32 m0, s10, 114688
  s_add_u32 s11, s3, s12
  buffer_load_dwordx4 v132, s[32:35], s11 offen offset:0 lds
  buffer_load_dwordx4 v133, s[32:35], s11 offen offset:1024 lds
  buffer_load_dwordx4 v134, s[32:35], s11 offen offset:2048 lds
  buffer_load_dwordx4 v135, s[32:35], s11 offen offset:3072 lds
  s_xor_b32 s3, s65, 1
  s_mul_i32 s3, s3, 229376
  s_add_u32 m0, s10, 8192
  s_add_u32 s11, s3, s12
  buffer_load_dwordx4 v128, s[32:35], s11 offen offset:0 lds
  buffer_load_dwordx4 v129, s[32:35], s11 offen offset:1024 lds
  buffer_load_dwordx4 v130, s[32:35], s11 offen offset:2048 lds
  buffer_load_dwordx4 v131, s[32:35], s11 offen offset:3072 lds
  s_mov_b32 m0, s20
  s_mov_b64 exec, 3
  buffer_load_dword off, s[32:35], s34 offset:272 lds
  s_mov_b64 exec, -1
  s_xor_b32 s3, s65, 2
  s_mul_i32 s3, s3, 229376
  s_add_u32 m0, s10, 16384
  s_add_u32 s11, s3, s12
  buffer_load_dwordx4 v128, s[32:35], s11 offen offset:0 lds
  buffer_load_dwordx4 v129, s[32:35], s11 offen offset:1024 lds
  buffer_load_dwordx4 v130, s[32:35], s11 offen offset:2048 lds
  buffer_load_dwordx4 v131, s[32:35], s11 offen offset:3072 lds
  s_mov_b32 m0, s20
  s_mov_b64 exec, 3
  buffer_load_dword off, s[32:35], s34 offset:288 lds
  s_mov_b64 exec, -1
  s_add_u32 m0, s10, 151552
s_nop 0
  buffer_load_dwordx4 v138, s[24:27], s13 offen offset:0 lds
  s_add_u32 s13, s13, 262144
  buffer_load_dwordx4 v138, s[24:27], s13 offen offset:1024 lds
  s_add_u32 s13, s13, 262144
  buffer_load_dwordx4 v138, s[24:27], s13 offen offset:2048 lds
  s_add_u32 s13, s13, 262144
  buffer_load_dwordx4 v138, s[24:27], s13 offen offset:3072 lds
  s_mov_b32 m0, s20
  s_mov_b64 exec, 3
  buffer_load_dword off, s[32:35], s34 offset:992 lds
  s_mov_b64 exec, -1
  v_lshl_add_u32 v8, v6, 6, s7
  v_cvt_f32_u32 v8, v8
  v_mul_f32 v8, 0xba000000, v8
  v_lshlrev_b32 v7, 2, v5
  v_cvt_f32_u32 v7, v7
  v_mul_f32 v7, v7, v8
  v_cos_f32 v248, v7
  v_sin_f32 v252, v7
  v_add_f32 v7, v7, v8
  v_cos_f32 v249, v7
  v_sin_f32 v253, v7
  v_add_f32 v7, v7, v8
  v_cos_f32 v250, v7
  v_sin_f32 v254, v7
  v_add_f32 v7, v7, v8
  v_cos_f32 v251, v7
  v_sin_f32 v255, v7
  v_add_f32 v7, v7, v8
  v_cvt_pk_bf16_f32 v112, v248, v249
  v_cvt_pk_bf16_f32 v114, v252, v253
  v_cvt_pk_bf16_f32 v113, v250, v251
  v_cvt_pk_bf16_f32 v115, v254, v255
  v_fma_f32 v7, v8, 4.0, v7
  v_cos_f32 v248, v7
  v_sin_f32 v252, v7
  v_add_f32 v7, v7, v8
  v_cos_f32 v249, v7
  v_sin_f32 v253, v7
  v_add_f32 v7, v7, v8
  v_cos_f32 v250, v7
  v_sin_f32 v254, v7
  v_add_f32 v7, v7, v8
  v_cos_f32 v251, v7
  v_sin_f32 v255, v7
  v_add_f32 v7, v7, v8
  v_cvt_pk_bf16_f32 v116, v248, v249
  v_cvt_pk_bf16_f32 v118, v252, v253
  v_cvt_pk_bf16_f32 v117, v250, v251
  v_cvt_pk_bf16_f32 v119, v254, v255
  v_fma_f32 v7, v8, 4.0, v7
  v_cos_f32 v248, v7
  v_sin_f32 v252, v7
  v_add_f32 v7, v7, v8
  v_cos_f32 v249, v7
  v_sin_f32 v253, v7
  v_add_f32 v7, v7, v8
  v_cos_f32 v250, v7
  v_sin_f32 v254, v7
  v_add_f32 v7, v7, v8
  v_cos_f32 v251, v7
  v_sin_f32 v255, v7
  v_add_f32 v7, v7, v8
  v_cvt_pk_bf16_f32 v120, v248, v249
  v_cvt_pk_bf16_f32 v122, v252, v253
  v_cvt_pk_bf16_f32 v121, v250, v251
  v_cvt_pk_bf16_f32 v123, v254, v255
  v_fma_f32 v7, v8, 4.0, v7
  v_cos_f32 v248, v7
  v_sin_f32 v252, v7
  v_add_f32 v7, v7, v8
  v_cos_f32 v249, v7
  v_sin_f32 v253, v7
  v_add_f32 v7, v7, v8
  v_cos_f32 v250, v7
  v_sin_f32 v254, v7
  v_add_f32 v7, v7, v8
  v_cos_f32 v251, v7
  v_sin_f32 v255, v7
  v_add_f32 v7, v7, v8
  v_cvt_pk_bf16_f32 v124, v248, v249
  v_cvt_pk_bf16_f32 v126, v252, v253
  v_cvt_pk_bf16_f32 v125, v250, v251
  v_cvt_pk_bf16_f32 v127, v254, v255
  s_xor_b32 s3, s65, 3
  s_mul_i32 s3, s3, 229376
  s_add_u32 m0, s10, 24576
  s_add_u32 s11, s3, s12
  buffer_load_dwordx4 v128, s[32:35], s11 offen offset:0 lds
  buffer_load_dwordx4 v129, s[32:35], s11 offen offset:1024 lds
  buffer_load_dwordx4 v130, s[32:35], s11 offen offset:2048 lds
  buffer_load_dwordx4 v131, s[32:35], s11 offen offset:3072 lds
  s_mov_b32 m0, s20
  s_mov_b64 exec, 3
  buffer_load_dword off, s[32:35], s34 offset:304 lds
  s_mov_b64 exec, -1
  s_waitcnt vmcnt(25)
  s_xor_b32 s3, s65, 4
  s_mul_i32 s3, s3, 229376
  s_add_u32 m0, s10, 32768
  s_add_u32 s11, s3, s12
  buffer_load_dwordx4 v128, s[32:35], s11 offen offset:0 lds
  buffer_load_dwordx4 v129, s[32:35], s11 offen offset:1024 lds
  buffer_load_dwordx4 v130, s[32:35], s11 offen offset:2048 lds
  buffer_load_dwordx4 v131, s[32:35], s11 offen offset:3072 lds
  s_mov_b32 m0, s20
  s_mov_b64 exec, 3
  buffer_load_dword off, s[32:35], s34 offset:320 lds
  s_mov_b64 exec, -1
  s_waitcnt vmcnt(25)
  s_xor_b32 s3, s65, 5
  s_mul_i32 s3, s3, 229376
  s_add_u32 m0, s10, 40960
  s_add_u32 s11, s3, s12
  buffer_load_dwordx4 v128, s[32:35], s11 offen offset:0 lds
  buffer_load_dwordx4 v129, s[32:35], s11 offen offset:1024 lds
  buffer_load_dwordx4 v130, s[32:35], s11 offen offset:2048 lds
  buffer_load_dwordx4 v131, s[32:35], s11 offen offset:3072 lds
  s_mov_b32 m0, s20
  s_mov_b64 exec, 3
  buffer_load_dword off, s[32:35], s34 offset:336 lds
  s_mov_b64 exec, -1
  ds_read_b32 v3, v1 offset:768
  s_waitcnt lgkmcnt(0)
  v_cmp_ne_u32 vcc, 0, v3
  s_cbranch_vccnz slow_lc38
back_lc38:
  s_waitcnt vmcnt(26)
  s_xor_b32 s3, s65, 6
  s_mul_i32 s3, s3, 229376
  s_add_u32 m0, s10, 49152
  s_add_u32 s11, s3, s12
  buffer_load_dwordx4 v128, s[32:35], s11 offen offset:0 lds
  buffer_load_dwordx4 v129, s[32:35], s11 offen offset:1024 lds
  buffer_load_dwordx4 v130, s[32:35], s11 offen offset:2048 lds
  buffer_load_dwordx4 v131, s[32:35], s11 offen offset:3072 lds
  s_mov_b32 m0, s20
  s_mov_b64 exec, 3
  buffer_load_dword off, s[32:35], s34 offset:352 lds
  s_mov_b64 exec, -1
  s_waitcnt vmcnt(26)
  s_xor_b32 s3, s65, 7
  s_mul_i32 s3, s3, 229376
  s_add_u32 m0, s10, 57344
  s_add_u32 s11, s3, s12
  buffer_load_dwordx4 v128, s[32:35], s11 offen offset:0 lds
  buffer_load_dwordx4 v129, s[32:35], s11 offen offset:1024 lds
  buffer_load_dwordx4 v130, s[32:35], s11 offen offset:2048 lds
  buffer_load_dwordx4 v131, s[32:35], s11 offen offset:3072 lds
  s_mov_b32 m0, s20
  s_mov_b64 exec, 3
  buffer_load_dword off, s[32:35], s34 offset:368 lds
  s_mov_b64 exec, -1
  buffer_load_dword v247, v139, s[52:55], s14 offen
  s_waitcnt vmcnt(22)
  s_xor_b32 s3, s65, 1
  s_mul_i32 s3, s3, 229376
  s_add_u32 m0, s10, 122880
  s_add_u32 s11, s3, s12
  buffer_load_dwordx4 v132, s[32:35], s11 offen offset:0 lds
  buffer_load_dwordx4 v133, s[32:35], s11 offen offset:1024 lds
  buffer_load_dwordx4 v134, s[32:35], s11 offen offset:2048 lds
  buffer_load_dwordx4 v135, s[32:35], s11 offen offset:3072 lds
  ds_read_b32 v3, v1 offset:784
  s_waitcnt lgkmcnt(0)
  v_cmp_ne_u32 vcc, 0, v3
  s_cbranch_vccnz slow_lc40
back_lc40:
  s_waitcnt vmcnt(21)
  s_xor_b32 s3, s65, 2
  s_mul_i32 s3, s3, 229376
  s_add_u32 m0, s10, 65536
  s_add_u32 s11, s3, s12
  buffer_load_dwordx4 v132, s[32:35], s11 offen offset:0 lds
  buffer_load_dwordx4 v133, s[32:35], s11 offen offset:1024 lds
  buffer_load_dwordx4 v134, s[32:35], s11 offen offset:2048 lds
  buffer_load_dwordx4 v135, s[32:35], s11 offen offset:3072 lds
  s_mov_b32 m0, s20
  s_mov_b64 exec, 3
  buffer_load_dword off, s[32:35], s34 offset:384 lds
  s_mov_b64 exec, -1
  s_waitcnt vmcnt(21)
  s_xor_b32 s3, s65, 3
  s_mul_i32 s3, s3, 229376
  s_add_u32 m0, s10, 73728
  s_add_u32 s11, s3, s12
  buffer_load_dwordx4 v132, s[32:35], s11 offen offset:0 lds
  buffer_load_dwordx4 v133, s[32:35], s11 offen offset:1024 lds
  buffer_load_dwordx4 v134, s[32:35], s11 offen offset:2048 lds
  buffer_load_dwordx4 v135, s[32:35], s11 offen offset:3072 lds
  ds_read_b32 v3, v1 offset:800
  s_waitcnt lgkmcnt(0)
  v_cmp_ne_u32 vcc, 0, v3
  s_cbranch_vccnz slow_lc42
back_lc42:
  s_waitcnt vmcnt(20)
  s_xor_b32 s3, s65, 4
  s_mul_i32 s3, s3, 229376
  s_add_u32 m0, s10, 81920
  s_add_u32 s11, s3, s12
  buffer_load_dwordx4 v132, s[32:35], s11 offen offset:0 lds
  buffer_load_dwordx4 v133, s[32:35], s11 offen offset:1024 lds
  buffer_load_dwordx4 v134, s[32:35], s11 offen offset:2048 lds
  buffer_load_dwordx4 v135, s[32:35], s11 offen offset:3072 lds
  s_mov_b32 m0, s20
  s_mov_b64 exec, 3
  buffer_load_dword off, s[32:35], s34 offset:400 lds
  s_mov_b64 exec, -1
  s_waitcnt vmcnt(20)
  s_xor_b32 s3, s65, 5
  s_mul_i32 s3, s3, 229376
  s_add_u32 m0, s10, 90112
  s_add_u32 s11, s3, s12
  buffer_load_dwordx4 v132, s[32:35], s11 offen offset:0 lds
  buffer_load_dwordx4 v133, s[32:35], s11 offen offset:1024 lds
  buffer_load_dwordx4 v134, s[32:35], s11 offen offset:2048 lds
  buffer_load_dwordx4 v135, s[32:35], s11 offen offset:3072 lds
  ds_read_b32 v3, v1 offset:816
  s_waitcnt lgkmcnt(0)
  v_cmp_ne_u32 vcc, 0, v3
  s_cbranch_vccnz slow_lc44
back_lc44:
  s_waitcnt vmcnt(18)
  s_xor_b32 s3, s65, 6
  s_mul_i32 s3, s3, 229376
  s_add_u32 m0, s10, 98304
  s_add_u32 s11, s3, s12
  buffer_load_dwordx4 v132, s[32:35], s11 offen offset:0 lds
  buffer_load_dwordx4 v133, s[32:35], s11 offen offset:1024 lds
  buffer_load_dwordx4 v134, s[32:35], s11 offen offset:2048 lds
  buffer_load_dwordx4 v135, s[32:35], s11 offen offset:3072 lds
  s_mov_b32 m0, s20
  s_mov_b64 exec, 3
  buffer_load_dword off, s[32:35], s34 offset:416 lds
  s_mov_b64 exec, -1
  s_waitcnt vmcnt(19)
  s_xor_b32 s3, s65, 7
  s_mul_i32 s3, s3, 229376
  s_add_u32 m0, s10, 106496
  s_add_u32 s11, s3, s12
  buffer_load_dwordx4 v132, s[32:35], s11 offen offset:0 lds
  buffer_load_dwordx4 v133, s[32:35], s11 offen offset:1024 lds
  buffer_load_dwordx4 v134, s[32:35], s11 offen offset:2048 lds
  buffer_load_dwordx4 v135, s[32:35], s11 offen offset:3072 lds
  s_mov_b32 m0, s20
  s_mov_b64 exec, 3
  buffer_load_dword off, s[32:35], s34 offset:432 lds
  s_mov_b64 exec, -1
  s_waitcnt vmcnt(19)
  s_waitcnt lgkmcnt(0)
  s_and_b32 s68, s68, -16
  s_add_u32 s68, s68, 17
  s_cmp_lg_u32 s8, 0
  s_cbranch_scc1 L_F3
  v_lshrrev_b32 v248, 4, v0
  v_bfe_u32 v249, v0, 2, 2
  v_xor_b32 v249, v249, v248
  v_lshlrev_b32 v248, 10, v248
  v_and_or_b32 v248, v2, 48, v248
  v_and_b32 v250, 1, v249
  v_lshl_add_u32 v248, v250, 6, v248
  v_and_b32 v250, 2, v249
  v_lshl_add_u32 v128, v250, 8, v248
  v_add_u32 v129, 3072, v128
  v_add_u32 v130, 6144, v128
  v_add_u32 v131, 9216, v128
  s_lshl_b32 s10, s6, 7
  s_mul_i32 s3, s5, 458752
  s_add_u32 s10, s10, s3
  s_xor_b32 s3, s6, 0
  s_lshl_b32 s3, s3, 2
  s_lshr_b32 s11, 0xc762a840, s3
  s_lshl_b32 s3, s11, 15
  s_and_b32 s3, s3, 491520
  s_add_u32 s12, s3, s10
  s_lshr_b32 s3, s11, 1
  s_and_b32 s3, s3, 491520
  s_add_u32 s16, s3, s10
  s_xor_b32 s3, s6, 1
  s_lshl_b32 s3, s3, 2
  s_lshr_b32 s11, 0xc762a840, s3
  s_lshl_b32 s3, s11, 15
  s_and_b32 s3, s3, 491520
  s_add_u32 s13, s3, s10
  s_lshr_b32 s3, s11, 1
  s_and_b32 s3, s3, 491520
  s_add_u32 s17, s3, s10
  s_xor_b32 s3, s6, 2
  s_lshl_b32 s3, s3, 2
  s_lshr_b32 s11, 0xc762a840, s3
  s_lshl_b32 s3, s11, 15
  s_and_b32 s3, s3, 491520
  s_add_u32 s14, s3, s10
  s_lshr_b32 s3, s11, 1
  s_and_b32 s3, s3, 491520
  s_add_u32 s18, s3, s10
  s_xor_b32 s3, s6, 3
  s_lshl_b32 s3, s3, 2
  s_lshr_b32 s11, 0xc762a840, s3
  s_lshl_b32 s3, s11, 15
  s_and_b32 s3, s3, 491520
  s_add_u32 s15, s3, s10
  s_lshr_b32 s3, s11, 1
  s_and_b32 s3, s3, 491520
  s_add_u32 s19, s3, s10
  ds_read_b32 v3, v1 offset:848
  s_waitcnt lgkmcnt(0)
  v_cmp_ne_u32 vcc, 0, v3
  s_cbranch_vccnz slow_lc46
back_lc46:
  s_mov_b32 m0, 131072
  s_add_u32 s11, s12, 0
  buffer_load_dwordx4 v128, s[52:55], s11 offen offset:0 lds
  buffer_load_dwordx4 v129, s[52:55], s11 offen offset:1024 lds
  buffer_load_dwordx4 v130, s[52:55], s11 offen offset:2048 lds
  buffer_load_dwordx4 v131, s[52:55], s11 offen offset:3072 lds
  s_mov_b32 m0, 135168
  s_add_u32 s11, s12, 16384
  buffer_load_dwordx4 v128, s[52:55], s11 offen offset:0 lds
  buffer_load_dwordx4 v129, s[52:55], s11 offen offset:1024 lds
  buffer_load_dwordx4 v130, s[52:55], s11 offen offset:2048 lds
  buffer_load_dwordx4 v131, s[52:55], s11 offen offset:3072 lds
  s_mov_b32 m0, 139264
  s_add_u32 s11, s12, 32768
  buffer_load_dwordx4 v128, s[52:55], s11 offen offset:0 lds
  buffer_load_dwordx4 v129, s[52:55], s11 offen offset:1024 lds
  buffer_load_dwordx4 v130, s[52:55], s11 offen offset:2048 lds
  buffer_load_dwordx4 v131, s[52:55], s11 offen offset:3072 lds
  ds_read_b32 v3, v1 offset:880
  s_waitcnt lgkmcnt(0)
  v_cmp_ne_u32 vcc, 0, v3
  s_cbranch_vccnz slow_lc48
back_lc48:
  s_mov_b32 m0, 151552
  s_add_u32 s11, s12, 49152
  buffer_load_dwordx4 v128, s[52:55], s11 offen offset:0 lds
  buffer_load_dwordx4 v129, s[52:55], s11 offen offset:1024 lds
  buffer_load_dwordx4 v130, s[52:55], s11 offen offset:2048 lds
  buffer_load_dwordx4 v131, s[52:55], s11 offen offset:3072 lds
  s_mov_b32 m0, 155648
  s_add_u32 s11, s16, 0
  buffer_load_dwordx4 v128, s[52:55], s11 offen offset:0 lds
  buffer_load_dwordx4 v129, s[52:55], s11 offen offset:1024 lds
  buffer_load_dwordx4 v130, s[52:55], s11 offen offset:2048 lds
  buffer_load_dwordx4 v131, s[52:55], s11 offen offset:3072 lds
  s_mov_b32 m0, 0x27000
  s_mov_b64 exec, 15
  buffer_load_dword off, s[52:55], s54 offset:512 lds
  s_mov_b64 exec, -1
  s_waitcnt vmcnt(17)
  ds_read_b32 v3, v1 offset:1008
  s_waitcnt lgkmcnt(0)
  v_cmp_ne_u32 vcc, 0, v3
  s_cbranch_vccnz slow_lc50
back_lc50:
  s_mov_b32 m0, 0
  s_add_u32 s11, s16, 16384
  buffer_load_dwordx4 v128, s[52:55], s11 offen offset:0 lds
  buffer_load_dwordx4 v129, s[52:55], s11 offen offset:1024 lds
  buffer_load_dwordx4 v130, s[52:55], s11 offen offset:2048 lds
  buffer_load_dwordx4 v131, s[52:55], s11 offen offset:3072 lds
  s_waitcnt vmcnt(17)
  s_mov_b32 m0, 4096
  s_add_u32 s11, s13, 0
  buffer_load_dwordx4 v128, s[52:55], s11 offen offset:0 lds
  buffer_load_dwordx4 v129, s[52:55], s11 offen offset:1024 lds
  buffer_load_dwordx4 v130, s[52:55], s11 offen offset:2048 lds
  buffer_load_dwordx4 v131, s[52:55], s11 offen offset:3072 lds
  s_waitcnt vmcnt(17)
  s_mov_b32 m0, 8192
  s_add_u32 s11, s13, 16384
  buffer_load_dwordx4 v128, s[52:55], s11 offen offset:0 lds
  buffer_load_dwordx4 v129, s[52:55], s11 offen offset:1024 lds
  buffer_load_dwordx4 v130, s[52:55], s11 offen offset:2048 lds
  buffer_load_dwordx4 v131, s[52:55], s11 offen offset:3072 lds
  s_waitcnt vmcnt(17)
  s_mov_b32 m0, 12288
  s_add_u32 s11, s14, 0
  buffer_load_dwordx4 v128, s[52:55], s11 offen offset:0 lds
  buffer_load_dwordx4 v129, s[52:55], s11 offen offset:1024 lds
  buffer_load_dwordx4 v130, s[52:55], s11 offen offset:2048 lds
  buffer_load_dwordx4 v131, s[52:55], s11 offen offset:3072 lds
  s_mov_b32 m0, 0x27000
  s_mov_b64 exec, 15
  buffer_load_dword off, s[52:55], s54 offset:528 lds
  s_mov_b64 exec, -1
  s_waitcnt vmcnt(18)
  s_mov_b32 m0, 16384
  s_add_u32 s11, s14, 16384
  buffer_load_dwordx4 v128, s[52:55], s11 offen offset:0 lds
  buffer_load_dwordx4 v129, s[52:55], s11 offen offset:1024 lds
  buffer_load_dwordx4 v130, s[52:55], s11 offen offset:2048 lds
  buffer_load_dwordx4 v131, s[52:55], s11 offen offset:3072 lds
  s_waitcnt vmcnt(17)
  s_mov_b32 m0, 20480
  s_add_u32 s11, s15, 0
  buffer_load_dwordx4 v128, s[52:55], s11 offen offset:0 lds
  buffer_load_dwordx4 v129, s[52:55], s11 offen offset:1024 lds
  buffer_load_dwordx4 v130, s[52:55], s11 offen offset:2048 lds
  buffer_load_dwordx4 v131, s[52:55], s11 offen offset:3072 lds
  s_waitcnt vmcnt(17)
  s_mov_b32 m0, 24576
  s_add_u32 s11, s15, 16384
  buffer_load_dwordx4 v128, s[52:55], s11 offen offset:0 lds
  buffer_load_dwordx4 v129, s[52:55], s11 offen offset:1024 lds
  buffer_load_dwordx4 v130, s[52:55], s11 offen offset:2048 lds
  buffer_load_dwordx4 v131, s[52:55], s11 offen offset:3072 lds
  s_waitcnt vmcnt(17)
  s_mov_b32 m0, 28672
  s_add_u32 s11, s13, 32768
  buffer_load_dwordx4 v128, s[52:55], s11 offen offset:0 lds
  buffer_load_dwordx4 v129, s[52:55], s11 offen offset:1024 lds
  buffer_load_dwordx4 v130, s[52:55], s11 offen offset:2048 lds
  buffer_load_dwordx4 v131, s[52:55], s11 offen offset:3072 lds
  s_mov_b32 m0, 0x27000
  s_mov_b64 exec, 15
  buffer_load_dword off, s[52:55], s54 offset:544 lds
  s_mov_b64 exec, -1
  s_waitcnt vmcnt(18)
  s_mov_b32 m0, 32768
  s_add_u32 s11, s13, 49152
  buffer_load_dwordx4 v128, s[52:55], s11 offen offset:0 lds
  buffer_load_dwordx4 v129, s[52:55], s11 offen offset:1024 lds
  buffer_load_dwordx4 v130, s[52:55], s11 offen offset:2048 lds
  buffer_load_dwordx4 v131, s[52:55], s11 offen offset:3072 lds
  s_waitcnt vmcnt(17)
  s_mov_b32 m0, 36864
  s_add_u32 s11, s14, 32768
  buffer_load_dwordx4 v128, s[52:55], s11 offen offset:0 lds
  buffer_load_dwordx4 v129, s[52:55], s11 offen offset:1024 lds
  buffer_load_dwordx4 v130, s[52:55], s11 offen offset:2048 lds
  buffer_load_dwordx4 v131, s[52:55], s11 offen offset:3072 lds
  s_waitcnt vmcnt(17)
  s_mov_b32 m0, 40960
  s_add_u32 s11, s14, 49152
  buffer_load_dwordx4 v128, s[52:55], s11 offen offset:0 lds
  buffer_load_dwordx4 v129, s[52:55], s11 offen offset:1024 lds
  buffer_load_dwordx4 v130, s[52:55], s11 offen offset:2048 lds
  buffer_load_dwordx4 v131, s[52:55], s11 offen offset:3072 lds
  s_waitcnt vmcnt(17)
  s_mov_b32 m0, 45056
  s_add_u32 s11, s15, 32768
  buffer_load_dwordx4 v128, s[52:55], s11 offen offset:0 lds
  buffer_load_dwordx4 v129, s[52:55], s11 offen offset:1024 lds
  buffer_load_dwordx4 v130, s[52:55], s11 offen offset:2048 lds
  buffer_load_dwordx4 v131, s[52:55], s11 offen offset:3072 lds
  s_mov_b32 m0, 0x27000
  s_mov_b64 exec, 15
  buffer_load_dword off, s[52:55], s54 offset:560 lds
  s_mov_b64 exec, -1
  s_waitcnt vmcnt(18)
  s_mov_b32 m0, 49152
  s_add_u32 s11, s15, 49152
  buffer_load_dwordx4 v128, s[52:55], s11 offen offset:0 lds
  buffer_load_dwordx4 v129, s[52:55], s11 offen offset:1024 lds
  buffer_load_dwordx4 v130, s[52:55], s11 offen offset:2048 lds
  buffer_load_dwordx4 v131, s[52:55], s11 offen offset:3072 lds
  s_waitcnt vmcnt(17)
  s_mov_b32 m0, 53248
  s_add_u32 s11, s17, 0
  buffer_load_dwordx4 v128, s[52:55], s11 offen offset:0 lds
  buffer_load_dwordx4 v129, s[52:55], s11 offen offset:1024 lds
  buffer_load_dwordx4 v130, s[52:55], s11 offen offset:2048 lds
  buffer_load_dwordx4 v131, s[52:55], s11 offen offset:3072 lds
  s_waitcnt vmcnt(17)
  s_mov_b32 m0, 57344
  s_add_u32 s11, s17, 16384
  buffer_load_dwordx4 v128, s[52:55], s11 offen offset:0 lds
  buffer_load_dwordx4 v129, s[52:55], s11 offen offset:1024 lds
  buffer_load_dwordx4 v130, s[52:55], s11 offen offset:2048 lds
  buffer_load_dwordx4 v131, s[52:55], s11 offen offset:3072 lds
  s_waitcnt vmcnt(17)
  s_mov_b32 m0, 61440
  s_add_u32 s11, s18, 0
  buffer_load_dwordx4 v128, s[52:55], s11 offen offset:0 lds
  buffer_load_dwordx4 v129, s[52:55], s11 offen offset:1024 lds
  buffer_load_dwordx4 v130, s[52:55], s11 offen offset:2048 lds
  buffer_load_dwordx4 v131, s[52:55], s11 offen offset:3072 lds
  s_mov_b32 m0, 0x27000
  s_mov_b64 exec, 15
  buffer_load_dword off, s[52:55], s54 offset:576 lds
  s_mov_b64 exec, -1
  s_waitcnt vmcnt(18)
  ds_read_b32 v3, v1 offset:48
  s_waitcnt lgkmcnt(0)
  v_cmp_gt_u32 vcc, 2, v3
  s_cbranch_vccnz slow_lc52
back_lc52:
  s_mov_b32 m0, 65536
  s_add_u32 s11, s18, 16384
  buffer_load_dwordx4 v128, s[52:55], s11 offen offset:0 lds
  buffer_load_dwordx4 v129, s[52:55], s11 offen offset:1024 lds
  buffer_load_dwordx4 v130, s[52:55], s11 offen offset:2048 lds
  buffer_load_dwordx4 v131, s[52:55], s11 offen offset:3072 lds
  s_waitcnt vmcnt(17)
  s_mov_b32 m0, 69632
  s_add_u32 s11, s19, 0
  buffer_load_dwordx4 v128, s[52:55], s11 offen offset:0 lds
  buffer_load_dwordx4 v129, s[52:55], s11 offen offset:1024 lds
  buffer_load_dwordx4 v130, s[52:55], s11 offen offset:2048 lds
  buffer_load_dwordx4 v131, s[52:55], s11 offen offset:3072 lds
  s_waitcnt vmcnt(17)
  s_mov_b32 m0, 73728
  s_add_u32 s11, s19, 16384
  buffer_load_dwordx4 v128, s[52:55], s11 offen offset:0 lds
  buffer_load_dwordx4 v129, s[52:55], s11 offen offset:1024 lds
  buffer_load_dwordx4 v130, s[52:55], s11 offen offset:2048 lds
  buffer_load_dwordx4 v131, s[52:55], s11 offen offset:3072 lds
  s_waitcnt vmcnt(17)
  s_mov_b32 m0, 77824
  s_add_u32 s11, s10, 98304
  buffer_load_dwordx4 v128, s[52:55], s11 offen offset:0 lds
  buffer_load_dwordx4 v129, s[52:55], s11 offen offset:1024 lds
  buffer_load_dwordx4 v130, s[52:55], s11 offen offset:2048 lds
  buffer_load_dwordx4 v131, s[52:55], s11 offen offset:3072 lds
  s_mov_b32 m0, 0x27000
  s_mov_b64 exec, 15
  buffer_load_dword off, s[52:55], s54 offset:592 lds
  s_mov_b64 exec, -1
  s_waitcnt vmcnt(18)
  s_mov_b32 m0, 81920
  s_add_u32 s11, s10, 114688
  buffer_load_dwordx4 v128, s[52:55], s11 offen offset:0 lds
  buffer_load_dwordx4 v129, s[52:55], s11 offen offset:1024 lds
  buffer_load_dwordx4 v130, s[52:55], s11 offen offset:2048 lds
  buffer_load_dwordx4 v131, s[52:55], s11 offen offset:3072 lds
  s_waitcnt vmcnt(17)
  s_mov_b32 m0, 86016
  s_add_u32 s11, s10, 425984
  buffer_load_dwordx4 v128, s[52:55], s11 offen offset:0 lds
  buffer_load_dwordx4 v129, s[52:55], s11 offen offset:1024 lds
  buffer_load_dwordx4 v130, s[52:55], s11 offen offset:2048 lds
  buffer_load_dwordx4 v131, s[52:55], s11 offen offset:3072 lds
  s_waitcnt vmcnt(17)
  s_mov_b32 m0, 90112
  s_add_u32 s11, s10, 442368
  buffer_load_dwordx4 v128, s[52:55], s11 offen offset:0 lds
  buffer_load_dwordx4 v129, s[52:55], s11 offen offset:1024 lds
  buffer_load_dwordx4 v130, s[52:55], s11 offen offset:2048 lds
  buffer_load_dwordx4 v131, s[52:55], s11 offen offset:3072 lds
  s_mov_b32 m0, 0x27000
  s_mov_b64 exec, 15
  buffer_load_dword off, s[52:55], s54 offset:608 lds
  s_mov_b64 exec, -1
  s_waitcnt vmcnt(18)
  s_branch L_p3
slow_lc36:
  ds_read_b32 v3, v1 offset:832
  s_add_u32 s67, s67, 1
  s_waitcnt lgkmcnt(0)
  v_cmp_ne_u32 vcc, 0, v3
  s_cmp_ge_u32 s67, 131072
  s_cbranch_scc1 back_lc36
  s_cbranch_vccnz slow_lc36
  s_branch back_lc36
slow_lc38:
  ds_read_b32 v3, v1 offset:768
  s_add_u32 s67, s67, 1
  s_waitcnt lgkmcnt(0)
  v_cmp_ne_u32 vcc, 0, v3
  s_cmp_ge_u32 s67, 131072
  s_cbranch_scc1 back_lc38
  s_cbranch_vccnz slow_lc38
  s_branch back_lc38
slow_lc40:
  ds_read_b32 v3, v1 offset:784
  s_add_u32 s67, s67, 1
  s_waitcnt lgkmcnt(0)
  v_cmp_ne_u32 vcc, 0, v3
  s_cmp_ge_u32 s67, 131072
  s_cbranch_scc1 back_lc40
  s_cbranch_vccnz slow_lc40
  s_branch back_lc40
slow_lc42:
  ds_read_b32 v3, v1 offset:800
  s_add_u32 s67, s67, 1
  s_waitcnt lgkmcnt(0)
  v_cmp_ne_u32 vcc, 0, v3
  s_cmp_ge_u32 s67, 131072
  s_cbranch_scc1 back_lc42
  s_cbranch_vccnz slow_lc42
  s_branch back_lc42
slow_lc44:
  ds_read_b32 v3, v1 offset:816
  s_add_u32 s67, s67, 1
  s_waitcnt lgkmcnt(0)
  v_cmp_ne_u32 vcc, 0, v3
  s_cmp_ge_u32 s67, 131072
  s_cbranch_scc1 back_lc44
  s_cbranch_vccnz slow_lc44
  s_branch back_lc44
slow_lc46:
  ds_read_b32 v3, v1 offset:848
  s_add_u32 s67, s67, 1
  s_waitcnt lgkmcnt(0)
  v_cmp_ne_u32 vcc, 0, v3
  s_cmp_ge_u32 s67, 131072
  s_cbranch_scc1 back_lc46
  s_cbranch_vccnz slow_lc46
  s_branch back_lc46
slow_lc48:
  ds_read_b32 v3, v1 offset:880
  s_add_u32 s67, s67, 1
  s_waitcnt lgkmcnt(0)
  v_cmp_ne_u32 vcc, 0, v3
  s_cmp_ge_u32 s67, 131072
  s_cbranch_scc1 back_lc48
  s_cbranch_vccnz slow_lc48
  s_branch back_lc48
slow_lc50:
  ds_read_b32 v3, v1 offset:1008
  s_add_u32 s67, s67, 1
  s_waitcnt lgkmcnt(0)
  v_cmp_ne_u32 vcc, 0, v3
  s_cmp_ge_u32 s67, 131072
  s_cbranch_scc1 back_lc50
  s_cbranch_vccnz slow_lc50
  s_branch back_lc50
slow_lc52:
  ds_read_b32 v3, v1 offset:48
  s_add_u32 s67, s67, 1
  s_waitcnt lgkmcnt(0)
  v_cmp_gt_u32 vcc, 2, v3
  s_cmp_ge_u32 s67, 131072
  s_cbranch_scc1 back_lc52
  s_cbranch_vccnz slow_lc52
  s_branch back_lc52
L_F3:
  s_cmp_lg_u32 s66, 0
  s_cbranch_scc1 L_F3e
  s_setprio 0
  s_lshl1_add_u32 s3, s66, s8
  s_cmp_lg_u32 s3, 1
  s_cbranch_scc1 L_noc
  v_bfe_i32 v248, v0, 2, 1
  v_and_b32 v248, 3, v248
  v_xor_b32 v176, v248, v0
  v_bfrev_b32 v248, v176
  v_lshrrev_b32 v248, 26, v248
  v_mul_u32_u24 v200, 16448, v248
  s_mul_i32 s3, s9, 514
  buffer_load_ushort v179, v200, s[44:47], s3 offen offset:512
  buffer_load_ushort v180, v200, s[48:51], s3 offen offset:512
  v_bfe_i32 v248, v176, 0, 1
  v_and_b32 v194, 0x80000000, v248
  v_or_b32 v194, 1.0, v194
  v_bfe_i32 v248, v176, 1, 1
  v_and_b32 v195, 0x80000000, v248
  v_or_b32 v195, 1.0, v195
  v_and_b32 v248, 3, v248
  v_and_b32 v248, v248, v176
  v_cvt_f32_u32 v248, v248
  v_mul_f32 v248, 0xbe800000, v248
  v_cos_f32 v184, v248
  v_sin_f32 v185, v248
  v_bfe_i32 v248, v176, 2, 1
  v_and_b32 v196, 0x80000000, v248
  v_or_b32 v196, 1.0, v196
  v_and_b32 v248, 7, v248
  v_and_b32 v248, v248, v176
  v_cvt_f32_u32 v248, v248
  v_mul_f32 v248, 0xbe000000, v248
  v_cos_f32 v186, v248
  v_sin_f32 v187, v248
  v_bfe_i32 v248, v176, 3, 1
  v_and_b32 v197, 0x80000000, v248
  v_or_b32 v197, 1.0, v197
  v_and_b32 v248, 15, v248
  v_and_b32 v248, v248, v176
  v_cvt_f32_u32 v248, v248
  v_mul_f32 v248, 0xbd800000, v248
  v_cos_f32 v188, v248
  v_sin_f32 v189, v248
  v_bfe_i32 v248, v176, 4, 1
  v_and_b32 v198, 0x80000000, v248
  v_or_b32 v198, 1.0, v198
  v_and_b32 v248, 31, v248
  v_and_b32 v248, v248, v176
  v_cvt_f32_u32 v248, v248
  v_mul_f32 v248, 0xbd000000, v248
  v_cos_f32 v190, v248
  v_sin_f32 v191, v248
  v_bfe_i32 v248, v176, 5, 1
  v_and_b32 v199, 0x80000000, v248
  v_or_b32 v199, 1.0, v199
  v_and_b32 v248, 63, v248
  v_and_b32 v248, v248, v176
  v_cvt_f32_u32 v248, v248
  v_mul_f32 v248, 0xbc800000, v248
  v_cos_f32 v192, v248
  v_sin_f32 v193, v248
L_noc:
  v_bfe_i32 v248, v0, 2, 1
  v_and_b32 v248, 3, v248
  v_xor_b32 v176, v248, v0
  s_lshl2_add_u32 s11, s9, 0x8000
  s_lshl_b32 s12, s9, 8
  s_add_u32 s12, s12, 0xa000
  s_lshl_b32 s13, s9, 12
  s_andn2_b32 s13, s13, 12288
  s_add_u32 s13, s13, 0x14c0000
  s_and_b32 s14, s9, 16
  s_lshl3_add_u32 s14, s14, 0x1450000
  s_mov_b32 s69, s68
  v_lshlrev_b32 v201, 7, v176
  v_lshlrev_b32 v202, 2, v176
  v_lshlrev_b32 v203, 11, v0
  v_mov_b32 v12, 1
L_mb1:
  s_buffer_load_dwordx8 s[28:35], s[36:39], s13 offset:0 glc
  s_buffer_load_dwordx8 s[40:47], s[36:39], s13 offset:128 glc
  s_buffer_load_dwordx8 s[48:55], s[36:39], s13 offset:256 glc
  s_buffer_load_dwordx8 s[20:27], s[36:39], s13 offset:384 glc
  s_add_u32 s67, s67, 8
  s_cmp_ge_u32 s67, 131072
  s_cbranch_scc1 L_mbx1
  s_waitcnt lgkmcnt(0)
  s_xor_b64 s[28:29], s[28:29], s[68:69]
  s_xor_b64 s[30:31], s[30:31], s[68:69]
  s_or_b64 s[28:29], s[28:29], s[30:31]
  s_xor_b64 s[32:33], s[32:33], s[68:69]
  s_or_b64 s[28:29], s[28:29], s[32:33]
  s_xor_b64 s[34:35], s[34:35], s[68:69]
  s_or_b64 s[28:29], s[28:29], s[34:35]
  s_xor_b64 s[40:41], s[40:41], s[68:69]
  s_or_b64 s[28:29], s[28:29], s[40:41]
  s_xor_b64 s[42:43], s[42:43], s[68:69]
  s_or_b64 s[28:29], s[28:29], s[42:43]
  s_xor_b64 s[44:45], s[44:45], s[68:69]
  s_or_b64 s[28:29], s[28:29], s[44:45]
  s_xor_b64 s[46:47], s[46:47], s[68:69]
  s_or_b64 s[28:29], s[28:29], s[46:47]
  s_xor_b64 s[48:49], s[48:49], s[68:69]
  s_or_b64 s[28:29], s[28:29], s[48:49]
  s_xor_b64 s[50:51], s[50:51], s[68:69]
  s_or_b64 s[28:29], s[28:29], s[50:51]
  s_xor_b64 s[52:53], s[52:53], s[68:69]
  s_or_b64 s[28:29], s[28:29], s[52:53]
  s_xor_b64 s[54:55], s[54:55], s[68:69]
  s_or_b64 s[28:29], s[28:29], s[54:55]
  s_xor_b64 s[20:21], s[20:21], s[68:69]
  s_or_b64 s[28:29], s[28:29], s[20:21]
  s_xor_b64 s[22:23], s[22:23], s[68:69]
  s_or_b64 s[28:29], s[28:29], s[22:23]
  s_xor_b64 s[24:25], s[24:25], s[68:69]
  s_or_b64 s[28:29], s[28:29], s[24:25]
  s_xor_b64 s[26:27], s[26:27], s[68:69]
  s_or_b64 s[28:29], s[28:29], s[26:27]
  s_cbranch_scc1 L_mb1
L_mbx1:
  s_setprio 1
  buffer_load_dword v178, v201, s[36:39], s11 offen sc1
  s_waitcnt vmcnt(1)
  v_lshlrev_b32 v179, 16, v179
  v_lshlrev_b32 v180, 16, v180
  s_waitcnt vmcnt(0)
  v_lshlrev_b32 v177, 16, v178
  v_and_b32 v178, 0xffff0000, v178
  v_mov_b32 v248, v177
  v_mov_b32 v249, v178
s_nop 0
  v_permlane32_swap_b32 v177, v248
  v_permlane32_swap_b32 v178, v249
  v_fma_f32 v177, v199, v177, v248
  v_fma_f32 v178, v199, v178, v249
  v_mul_f32 v250, v178, v193
  v_mul_f32 v251, v177, v193
  v_fma_f32 v177, v177, v192, -v250
  v_fma_f32 v178, v178, v192, v251
  v_mov_b32 v248, v177
  v_mov_b32 v249, v178
s_nop 0
  v_permlane16_swap_b32 v177, v248
  v_permlane16_swap_b32 v178, v249
  v_fma_f32 v177, v198, v177, v248
  v_fma_f32 v178, v198, v178, v249
  v_mul_f32 v250, v178, v191
  v_mul_f32 v251, v177, v191
  v_fma_f32 v177, v177, v190, -v250
  v_fma_f32 v178, v178, v190, v251
s_nop 0
  v_fmac_f32_dpp v177, v177, v197 row_ror:8 row_mask:0xf bank_mask:0xf
  v_fmac_f32_dpp v178, v178, v197 row_ror:8 row_mask:0xf bank_mask:0xf
  v_mul_f32 v250, v178, v189
  v_mul_f32 v251, v177, v189
  v_fma_f32 v177, v177, v188, -v250
  v_fma_f32 v178, v178, v188, v251
s_nop 0
  v_fmac_f32_dpp v177, v177, v196 row_half_mirror row_mask:0xf bank_mask:0xf
  v_fmac_f32_dpp v178, v178, v196 row_half_mirror row_mask:0xf bank_mask:0xf
  v_mul_f32 v250, v178, v187
  v_mul_f32 v251, v177, v187
  v_fma_f32 v177, v177, v186, -v250
  v_fma_f32 v178, v178, v186, v251
s_nop 0
  v_fmac_f32_dpp v177, v177, v195 quad_perm:[2,3,0,1] row_mask:0xf bank_mask:0xf
  v_fmac_f32_dpp v178, v178, v195 quad_perm:[2,3,0,1] row_mask:0xf bank_mask:0xf
  v_mul_f32 v250, v178, v185
  v_mul_f32 v251, v177, v185
  v_fma_f32 v177, v177, v184, -v250
  v_fma_f32 v178, v178, v184, v251
s_nop 0
  v_fmac_f32_dpp v177, v177, v194 quad_perm:[1,0,3,2] row_mask:0xf bank_mask:0xf
  v_fmac_f32_dpp v178, v178, v194 quad_perm:[1,0,3,2] row_mask:0xf bank_mask:0xf
  v_mul_f32 v250, v178, v180
  v_mul_f32 v251, v177, v180
  v_fma_f32 v177, v177, v179, -v250
  v_fma_f32 v178, v178, v179, v251
s_nop 0
  v_fmac_f32_dpp v177, v177, -v194 quad_perm:[1,0,3,2] row_mask:0xf bank_mask:0xf
  v_fmac_f32_dpp v178, v178, -v194 quad_perm:[1,0,3,2] row_mask:0xf bank_mask:0xf
  v_mul_f32 v250, v178, v185
  v_mul_f32 v251, v177, v185
  v_fma_f32 v177, v177, v184, v250
  v_fma_f32 v178, v178, v184, -v251
s_nop 0
  v_fmac_f32_dpp v177, v177, -v195 quad_perm:[2,3,0,1] row_mask:0xf bank_mask:0xf
  v_fmac_f32_dpp v178, v178, -v195 quad_perm:[2,3,0,1] row_mask:0xf bank_mask:0xf
  v_mul_f32 v250, v178, v187
  v_mul_f32 v251, v177, v187
  v_fma_f32 v177, v177, v186, v250
  v_fma_f32 v178, v178, v186, -v251
s_nop 0
  v_fmac_f32_dpp v177, v177, -v196 row_half_mirror row_mask:0xf bank_mask:0xf
  v_fmac_f32_dpp v178, v178, -v196 row_half_mirror row_mask:0xf bank_mask:0xf
  v_mul_f32 v250, v178, v189
  v_mul_f32 v251, v177, v189
  v_fma_f32 v177, v177, v188, v250
  v_fma_f32 v178, v178, v188, -v251
s_nop 0
  v_fmac_f32_dpp v177, v177, -v197 row_ror:8 row_mask:0xf bank_mask:0xf
  v_fmac_f32_dpp v178, v178, -v197 row_ror:8 row_mask:0xf bank_mask:0xf
  v_mul_f32 v250, v178, v191
  v_mul_f32 v251, v177, v191
  v_fma_f32 v177, v177, v190, v250
  v_fma_f32 v178, v178, v190, -v251
  v_mov_b32 v248, v177
  v_mov_b32 v249, v178
s_nop 0
  v_permlane16_swap_b32 v177, v248
  v_permlane16_swap_b32 v178, v249
  v_fma_f32 v177, -v198, v248, v177
  v_fma_f32 v178, -v198, v249, v178
  v_mul_f32 v250, v178, v193
  v_mul_f32 v251, v177, v193
  v_fma_f32 v177, v177, v192, v250
  v_fma_f32 v178, v178, v192, -v251
  v_mov_b32 v248, v177
  v_mov_b32 v249, v178
s_nop 0
  v_permlane32_swap_b32 v177, v248
  v_permlane32_swap_b32 v178, v249
  v_fma_f32 v177, -v199, v248, v177
  v_fma_f32 v178, -v199, v249, v178
  v_cvt_pk_bf16_f32 v177, v177, v178
  buffer_store_dword v177, v202, s[36:39], s12 offen sc1
  s_waitcnt vmcnt(0)
  buffer_atomic_add v12, v203, s[36:39], s14 offen sc1
  s_setprio 0
L_F3e:
  ds_read_b32 v3, v1 offset:48
  s_waitcnt lgkmcnt(0)
  v_cmp_gt_u32 vcc, 2, v3
  s_cbranch_vccnz slow_lc54
back_lc54:
L_p3:
  s_setprio 0
  s_lshl2_add_u32 s3, s7, s4
  s_lshl_b32 s10, s3, 9
  s_add_u32 s10, s10, 0x1450000
  ds_read_b32 v3, v1 offset:48
  s_waitcnt lgkmcnt(0)
  v_cmp_gt_u32 vcc, 3, v3
  s_cbranch_vccnz slow_lc56
back_lc56:
  v_add_u32 v245, 139264, v2
  s_cmp_lg_u32 s4, 3
  s_cbranch_scc1 L_e3
  ds_write_b128 v245, v[112:115] offset:0
  ds_write_b128 v245, v[116:119] offset:1024
  ds_write_b128 v245, v[120:123] offset:2048
  ds_write_b128 v245, v[124:127] offset:3072
L_e3:
  s_xor_b32 s20, s10, 0
  s_buffer_load_dword s20, s[36:39], s20 glc
  s_xor_b32 s21, s10, 128
  s_buffer_load_dword s21, s[36:39], s21 glc
  s_xor_b32 s22, s10, 256
  s_buffer_load_dword s22, s[36:39], s22 glc
  s_xor_b32 s23, s10, 384
  s_buffer_load_dword s23, s[36:39], s23 glc
  s_mul_i32 s11, s7, 32896
  s_add_u32 s11, s11, 0x210000
  s_lshl_b32 s3, s4, 13
  s_add_u32 s12, s11, s3
  s_add_u32 s13, s12, 0x1000
  s_add_u32 s14, s3, 94208
  v_and_b32 v240, 48, v0
  v_xor_b32 v240, v240, v2
  v_xor_b32 v241, 64, v240
  s_lshl2_add_u32 s15, s4, 159744
  v_mov_b32 v4, s15
  v_mov_b32 v12, 1
  v_lshl_or_b32 v249, v5, 2, s8
  v_bfe_u32 v250, v0, 1, 3
  v_xor_b32 v249, v249, v250
  v_lshlrev_b32 v249, 4, v249
  v_lshl_add_u32 v249, v6, 7, v249
  v_add_u32 v242, 94208, v249
  v_xor_b32 v243, 32, v242
  v_lshlrev_b32 v244, 8, v6
  s_lshl2_add_u32 s16, s7, 0xa000
  s_lshl_b32 s3, s5, 8
  s_add_u32 s3, s3, 161792
  v_lshl_add_u32 v11, v0, 2, s3
  s_mov_b32 m0, s14
  s_waitcnt lgkmcnt(0)
  s_sub_u32 s20, s20, s68
  s_sub_u32 s21, s21, s68
  s_or_b32 s20, s20, s21
  s_sub_u32 s22, s22, s68
  s_or_b32 s20, s20, s22
  s_sub_u32 s23, s23, s68
  s_or_b32 s20, s20, s23
  s_cmp_ge_u32 s20, 1
  s_cbranch_scc1 slow_sc57
back_sc57:
  buffer_load_dwordx4 v240, s[36:39], s12 offen offset:0 sc1 lds
  buffer_load_dwordx4 v241, s[36:39], s12 offen offset:1024 sc1 lds
  buffer_load_dwordx4 v240, s[36:39], s12 offen offset:2048 sc1 lds
  buffer_load_dwordx4 v241, s[36:39], s12 offen offset:3072 sc1 lds
  s_mov_b32 m0, s15
  s_mov_b64 exec, 1
  buffer_load_dword off, s[36:39], s38 offset:896 lds
  s_mov_b64 exec, -1
  s_add_u32 m0, s14, 0x1000
s_nop 0
  buffer_load_dwordx4 v240, s[36:39], s13 offen offset:0 sc1 lds
  buffer_load_dwordx4 v241, s[36:39], s13 offen offset:1024 sc1 lds
  buffer_load_dwordx4 v240, s[36:39], s13 offen offset:2048 sc1 lds
  buffer_load_dwordx4 v241, s[36:39], s13 offen offset:3072 sc1 lds
  s_cmp_lg_u32 s4, 0
  s_cbranch_scc1 L_noq
  s_mov_b32 m0, 160768
  s_nop 0
s_nop 0
  buffer_load_dword v244, s[36:39], s16 offen sc1 lds
L_noq:
  s_mov_b32 m0, s15
  s_mov_b64 exec, 1
  buffer_load_dword off, s[36:39], s38 offset:912 lds
  s_mov_b64 exec, -1
  ds_read_b32 v11, v11
  s_lshl_b32 s3, s4, 11
  s_add_u32 s3, s3, 143360
  v_add_u32 v248, s3, v2
  v_xor_b32 v249, 0x800, v248
  v_lshlrev_b32 v250, 4, v5
  v_add_u32 v251, 160768, v250
  v_add_u32 v13, 0x1000, v2
  s_lshl4_add_u32 s3, s63, s64
  s_lshl_b32 s16, s3, 7
  s_add_u32 s16, s16, 0x14a0000
  s_lshl_b32 s3, s3, 5
  s_add_u32 s3, s3, s4
  s_lshl_b32 s3, s3, 10
  s_lshl_b32 s28, s5, 13
  s_add_u32 s3, s3, s28
  s_add_u32 s3, s3, 0xc20000
  s_xor_b32 s29, s3, 8192
  s_xor_b32 s30, s3, 16384
  s_xor_b32 s31, s3, 24576
  s_lshl_b32 s3, s4, 10
  s_add_u32 s3, s3, 131072
  v_add_u32 v14, s3, v2
  s_mov_b64 s[20:21], 0
  s_mov_b64 s[22:23], 0
  s_mov_b32 s69, s68
  s_mov_b32 s18, 0
  v_lshl_add_u32 v250, v6, 16, v250
  s_lshl3_add_u32 s3, s7, s6
  s_lshl2_add_u32 s3, s3, s4
  s_lshl_b32 s17, s3, 5
  s_lshl_b32 s19, s8, 31
  s_xor_b32 s19, s19, 0x36000000
  s_mov_b32 s24, 0x05040100
  s_mov_b32 s25, 0x07060302
  s_waitcnt lgkmcnt(0)
  v_sub_f32 v252, 1.0, v11
  v_cvt_pk_bf16_f32 v252, v252, v252
  v_and_b32 v253, 0xffff0000, v252
  v_lshrrev_b32 v252, 16, v252
  v_mul_f32 v254, 0x36000000, v11
  v_mul_f32 v11, s19, v11
  ds_read_b32 v3, v1 offset:896
  s_waitcnt lgkmcnt(0)
  v_cmp_ne_u32 vcc, 0, v3
  s_cbranch_vccnz slow_lc59
back_lc59:
  ds_read_b128 v[128:131], v242 offset:0
  ds_read_b128 v[132:135], v243 offset:0
  ds_read_b128 v[136:139], v242 offset:8192
  ds_read_b128 v[140:143], v243 offset:8192
  ds_read_b128 v[144:147], v242 offset:16384
  ds_read_b128 v[148:151], v243 offset:16384
  ds_read_b128 v[152:155], v242 offset:24576
  ds_read_b128 v[156:159], v243 offset:24576
  s_waitcnt lgkmcnt(7)
  v_mfma_f32_32x32x16_bf16 v[192:207], v[128:131], v[18:21], 0
  v_mfma_f32_32x32x16_bf16 v[208:223], v[128:131], v[16:19], 0
  s_waitcnt lgkmcnt(6)
  v_mfma_f32_32x32x16_bf16 v[192:207], v[132:135], v[24:27], v[192:207]
  v_mfma_f32_32x32x16_bf16 v[208:223], v[132:135], v[22:25], v[208:223]
  ds_read_b32 v3, v1 offset:912
  s_waitcnt lgkmcnt(6)
  v_mfma_f32_32x32x16_bf16 v[192:207], v[136:139], v[42:45], v[192:207]
  v_mfma_f32_32x32x16_bf16 v[208:223], v[136:139], v[40:43], v[208:223]
  s_waitcnt lgkmcnt(5)
  v_mfma_f32_32x32x16_bf16 v[192:207], v[140:143], v[48:51], v[192:207]
  v_mfma_f32_32x32x16_bf16 v[208:223], v[140:143], v[46:49], v[208:223]
  s_waitcnt lgkmcnt(0)
  v_cmp_ne_u32 vcc, 0, v3
  s_cbranch_vccnz slow_lc61
back_lc61:
  ds_read_b128 v[160:163], v242 offset:4096
  ds_read_b128 v[164:167], v243 offset:4096
  ds_read_b128 v[168:171], v242 offset:12288
  ds_read_b128 v[172:175], v243 offset:12288
  ds_read_b128 v[176:179], v242 offset:20480
  ds_read_b128 v[180:183], v243 offset:20480
  ds_read_b128 v[184:187], v242 offset:28672
  ds_read_b128 v[188:191], v243 offset:28672
  v_mfma_f32_32x32x16_bf16 v[192:207], v[144:147], v[66:69], v[192:207]
  v_mfma_f32_32x32x16_bf16 v[208:223], v[144:147], v[64:67], v[208:223]
  v_mfma_f32_32x32x16_bf16 v[192:207], v[148:151], v[72:75], v[192:207]
  v_mfma_f32_32x32x16_bf16 v[208:223], v[148:151], v[70:73], v[208:223]
  s_cmp_lg_u32 s4, 3
  s_cbranch_scc1 L_q0
  ds_read_b128 v[128:131], v251 offset:0
  ds_read_b128 v[132:135], v251 offset:32
  ds_read_b128 v[136:139], v251 offset:64
  ds_read_b128 v[140:143], v251 offset:96
L_q0:
  v_mfma_f32_32x32x16_bf16 v[192:207], v[152:155], v[90:93], v[192:207]
  v_mfma_f32_32x32x16_bf16 v[208:223], v[152:155], v[88:91], v[208:223]
  v_mfma_f32_32x32x16_bf16 v[192:207], v[156:159], v[96:99], v[192:207]
  v_mfma_f32_32x32x16_bf16 v[208:223], v[156:159], v[94:97], v[208:223]
  s_waitcnt lgkmcnt(7)
  v_mfma_f32_32x32x16_bf16 v[192:207], v[160:163], v[30:33], v[192:207]
  v_mfma_f32_32x32x16_bf16 v[208:223], v[160:163], v[28:31], v[208:223]
  s_cmp_lg_u32 s4, 3
  s_cbranch_scc1 L_q1
  s_waitcnt lgkmcnt(0)
  v_perm_b32 v144, v129, v128, s24
  v_perm_b32 v145, v131, v130, s24
  v_perm_b32 v146, v129, v128, s25
  v_perm_b32 v147, v131, v130, s25
  v_perm_b32 v148, v133, v132, s24
  v_perm_b32 v149, v135, v134, s24
  v_perm_b32 v150, v133, v132, s25
  v_perm_b32 v151, v135, v134, s25
  v_perm_b32 v152, v137, v136, s24
  v_perm_b32 v153, v139, v138, s24
  v_perm_b32 v154, v137, v136, s25
  v_perm_b32 v155, v139, v138, s25
  v_perm_b32 v156, v141, v140, s24
  v_perm_b32 v157, v143, v142, s24
  v_perm_b32 v158, v141, v140, s25
  v_perm_b32 v159, v143, v142, s25
s_nop 1
  v_mfma_f32_32x32x16_bf16 v[224:239], v[144:147], v[112:115], 0
  v_mfma_f32_32x32x16_bf16 v[224:239], v[148:151], v[116:119], v[224:239]
  v_mfma_f32_32x32x16_bf16 v[224:239], v[152:155], v[120:123], v[224:239]
  v_mfma_f32_32x32x16_bf16 v[224:239], v[156:159], v[124:127], v[224:239]
L_q1:
  s_waitcnt lgkmcnt(6)
  v_mfma_f32_32x32x16_bf16 v[192:207], v[164:167], v[36:39], v[192:207]
  v_mfma_f32_32x32x16_bf16 v[208:223], v[164:167], v[34:37], v[208:223]
  s_waitcnt lgkmcnt(5)
  v_mfma_f32_32x32x16_bf16 v[192:207], v[168:171], v[54:57], v[192:207]
  v_mfma_f32_32x32x16_bf16 v[208:223], v[168:171], v[52:55], v[208:223]
  ds_read_b128 v[112:115], v245 offset:0
  ds_read_b128 v[116:119], v245 offset:1024
  ds_read_b128 v[120:123], v245 offset:2048
  ds_read_b128 v[124:127], v245 offset:3072
  s_waitcnt lgkmcnt(8)
  v_mfma_f32_32x32x16_bf16 v[192:207], v[172:175], v[60:63], v[192:207]
  v_mfma_f32_32x32x16_bf16 v[208:223], v[172:175], v[58:61], v[208:223]
  v_lshlrev_b32 v244, 2, v0
  v_add_u32 v244, 162816, v244
  s_cmp_lg_u32 s4, 3
  s_cbranch_scc1 L_q2
  v_mul_f32 v255, v254, v224
  v_mul_f32 v255, 0.5, v255
  ds_write_b32 v244, v255
  ds_write_b32 v1, v12 offset:80
L_q2:
  s_waitcnt lgkmcnt(7)
  v_mfma_f32_32x32x16_bf16 v[192:207], v[176:179], v[78:81], v[192:207]
  v_mfma_f32_32x32x16_bf16 v[208:223], v[176:179], v[76:79], v[208:223]
  s_waitcnt lgkmcnt(6)
  v_mfma_f32_32x32x16_bf16 v[192:207], v[180:183], v[84:87], v[192:207]
  v_mfma_f32_32x32x16_bf16 v[208:223], v[180:183], v[82:85], v[208:223]
  s_waitcnt lgkmcnt(5)
  v_mfma_f32_32x32x16_bf16 v[192:207], v[184:187], v[102:105], v[192:207]
  v_mfma_f32_32x32x16_bf16 v[208:223], v[184:187], v[100:103], v[208:223]
  ds_read_b32 v3, v1 offset:80
  s_waitcnt lgkmcnt(5)
  v_mfma_f32_32x32x16_bf16 v[192:207], v[188:191], v[108:111], v[192:207]
  v_mfma_f32_32x32x16_bf16 v[208:223], v[188:191], v[106:109], v[208:223]
  s_waitcnt lgkmcnt(1)
  s_waitcnt lgkmcnt(0)
  v_cmp_gt_u32 vcc, 1, v3
  s_cbranch_vccnz slow_lc63
back_lc63:
  ds_read_b32 v255, v244
  v_cvt_pk_bf16_f32 v128, v192, v193
s_nop 5
  v_cvt_pk_bf16_f32 v130, v208, v209
  v_cvt_pk_bf16_f32 v129, v194, v195
  v_cvt_pk_bf16_f32 v131, v210, v211
  s_waitcnt lgkmcnt(0)
  s_buffer_load_dwordx4 s[20:23], s[36:39], s16 offset:0 glc
  v_cvt_pk_bf16_f32 v132, v196, v197
  v_cvt_pk_bf16_f32 v134, v212, v213
  v_cvt_pk_bf16_f32 v133, v198, v199
  v_cvt_pk_bf16_f32 v135, v214, v215
  v_mfma_f32_32x32x16_bf16 v[224:239], v[128:131], v[112:115], 0
  v_cvt_pk_bf16_f32 v136, v200, v201
  v_cvt_pk_bf16_f32 v138, v216, v217
  v_cvt_pk_bf16_f32 v137, v202, v203
  v_cvt_pk_bf16_f32 v139, v218, v219
  v_mfma_f32_32x32x16_bf16 v[224:239], v[132:135], v[116:119], v[224:239]
  v_cvt_pk_bf16_f32 v140, v204, v205
  v_cvt_pk_bf16_f32 v142, v220, v221
  v_cvt_pk_bf16_f32 v141, v206, v207
  v_cvt_pk_bf16_f32 v143, v222, v223
  v_mfma_f32_32x32x16_bf16 v[224:239], v[136:139], v[120:123], v[224:239]
s_nop 0
  v_mfma_f32_32x32x16_bf16 v[224:239], v[140:143], v[124:127], v[224:239]
s_nop 11
  ds_write_b128 v248, v[232:235] offset:0
  ds_write_b128 v248, v[236:239] offset:1024
  ds_write_b32 v4, v12 offset:112
  v_fma_f32 v200, v11, v224, v255
  v_fma_f32 v192, v254, v224, v255
  v_fma_f32 v201, v11, v225, -v255
  v_fma_f32 v193, v254, v225, -v255
  v_fma_f32 v202, v11, v226, v255
  v_fma_f32 v194, v254, v226, v255
  v_fma_f32 v203, v11, v227, -v255
  v_fma_f32 v195, v254, v227, -v255
  v_fma_f32 v204, v11, v228, v255
  v_fma_f32 v196, v254, v228, v255
  v_fma_f32 v205, v11, v229, -v255
  v_fma_f32 v197, v254, v229, -v255
  v_fma_f32 v206, v11, v230, v255
  v_fma_f32 v198, v254, v230, v255
  v_fma_f32 v207, v11, v231, -v255
  v_fma_f32 v199, v254, v231, -v255
  ds_read_b32 v3, v1 offset:112
  s_waitcnt lgkmcnt(0)
  v_cmp_gt_u32 vcc, 1, v3
  s_cbranch_vccnz slow_lc65
back_lc65:
  ds_read_b128 v[208:211], v249 offset:0
  ds_read_b128 v[212:215], v249 offset:1024
  s_waitcnt lgkmcnt(0)
  s_cmp_lg_u32 s18, 0
  s_cbranch_scc1 pt66
  s_xor_b64 s[40:41], s[20:21], s[68:69]
  s_xor_b64 s[42:43], s[22:23], s[68:69]
  s_or_b64 s[40:41], s[40:41], s[42:43]
  s_cbranch_scc1 pt66_no
pt66_go:
  s_mov_b32 s18, 1
  buffer_load_dwordx4 v[40:43], v2, s[36:39], s29 offen sc1
  buffer_load_dwordx4 v[44:47], v13, s[36:39], s29 offen sc1
  buffer_load_dwordx4 v[48:51], v2, s[36:39], s30 offen sc1
  buffer_load_dwordx4 v[52:55], v13, s[36:39], s30 offen sc1
  buffer_load_dwordx4 v[56:59], v2, s[36:39], s31 offen sc1
  buffer_load_dwordx4 v[60:63], v13, s[36:39], s31 offen sc1
  s_branch pt66
pt66_no:
  s_buffer_load_dwordx4 s[20:23], s[36:39], s16 offset:0 glc
pt66:
  v_fmac_f32 v192, v254, v208
  v_fma_f32 v200, -v11, v208, v200
  v_fmac_f32 v193, v254, v209
  v_fma_f32 v201, -v11, v209, v201
  v_fmac_f32 v194, v254, v210
  v_fma_f32 v202, -v11, v210, v202
  v_fmac_f32 v195, v254, v211
  v_fma_f32 v203, -v11, v211, v203
  v_fmac_f32 v196, v254, v212
  v_fma_f32 v204, -v11, v212, v204
  v_fmac_f32 v197, v254, v213
  v_fma_f32 v205, -v11, v213, v205
  v_fmac_f32 v198, v254, v214
  v_fma_f32 v206, -v11, v214, v206
  v_fmac_f32 v199, v254, v215
  v_fma_f32 v207, -v11, v215, v207
  s_cmp_eq_u32 s18, 1
  s_cbranch_scc1 L_pl
  s_branch slow_p
back_p:
  buffer_load_dwordx4 v[40:43], v2, s[36:39], s29 offen sc1
  buffer_load_dwordx4 v[44:47], v13, s[36:39], s29 offen sc1
  buffer_load_dwordx4 v[48:51], v2, s[36:39], s30 offen sc1
  buffer_load_dwordx4 v[52:55], v13, s[36:39], s30 offen sc1
  buffer_load_dwordx4 v[56:59], v2, s[36:39], s31 offen sc1
  buffer_load_dwordx4 v[60:63], v13, s[36:39], s31 offen sc1
L_pl:
  ds_read_b128 v[32:35], v14 offset:0
  ds_read_b128 v[36:39], v14 offset:4096
  s_waitcnt lgkmcnt(1)
  v_dot2_f32_bf16 v192, v32, v252, v192
  v_dot2_f32_bf16 v193, v32, v253, v193
  v_dot2_f32_bf16 v194, v33, v252, v194
  v_dot2_f32_bf16 v195, v33, v253, v195
  v_dot2_f32_bf16 v196, v34, v252, v196
  v_dot2_f32_bf16 v197, v34, v253, v197
  v_dot2_f32_bf16 v198, v35, v252, v198
  v_dot2_f32_bf16 v199, v35, v253, v199
  s_waitcnt lgkmcnt(0)
  v_dot2_f32_bf16 v200, v36, v252, v200
  v_dot2_f32_bf16 v201, v36, v253, v201
  v_dot2_f32_bf16 v202, v37, v252, v202
  v_dot2_f32_bf16 v203, v37, v253, v203
  v_dot2_f32_bf16 v204, v38, v252, v204
  v_dot2_f32_bf16 v205, v38, v253, v205
  v_dot2_f32_bf16 v206, v39, v252, v206
  v_dot2_f32_bf16 v207, v39, v253, v207
  s_waitcnt vmcnt(5)
  v_dot2_f32_bf16 v192, v40, v252, v192
  v_dot2_f32_bf16 v193, v40, v253, v193
  v_dot2_f32_bf16 v194, v41, v252, v194
  v_dot2_f32_bf16 v195, v41, v253, v195
  v_dot2_f32_bf16 v196, v42, v252, v196
  v_dot2_f32_bf16 v197, v42, v253, v197
  v_dot2_f32_bf16 v198, v43, v252, v198
  v_dot2_f32_bf16 v199, v43, v253, v199
  s_waitcnt vmcnt(4)
  v_dot2_f32_bf16 v200, v44, v252, v200
  v_dot2_f32_bf16 v201, v44, v253, v201
  v_dot2_f32_bf16 v202, v45, v252, v202
  v_dot2_f32_bf16 v203, v45, v253, v203
  v_dot2_f32_bf16 v204, v46, v252, v204
  v_dot2_f32_bf16 v205, v46, v253, v205
  v_dot2_f32_bf16 v206, v47, v252, v206
  v_dot2_f32_bf16 v207, v47, v253, v207
  s_waitcnt vmcnt(3)
  v_dot2_f32_bf16 v192, v48, v252, v192
  v_dot2_f32_bf16 v193, v48, v253, v193
  v_dot2_f32_bf16 v194, v49, v252, v194
  v_dot2_f32_bf16 v195, v49, v253, v195
  v_dot2_f32_bf16 v196, v50, v252, v196
  v_dot2_f32_bf16 v197, v50, v253, v197
  v_dot2_f32_bf16 v198, v51, v252, v198
  v_dot2_f32_bf16 v199, v51, v253, v199
  s_waitcnt vmcnt(2)
  v_dot2_f32_bf16 v200, v52, v252, v200
  v_dot2_f32_bf16 v201, v52, v253, v201
  v_dot2_f32_bf16 v202, v53, v252, v202
  v_dot2_f32_bf16 v203, v53, v253, v203
  v_dot2_f32_bf16 v204, v54, v252, v204
  v_dot2_f32_bf16 v205, v54, v253, v205
  v_dot2_f32_bf16 v206, v55, v252, v206
  v_dot2_f32_bf16 v207, v55, v253, v207
  s_waitcnt vmcnt(1)
  v_dot2_f32_bf16 v192, v56, v252, v192
  v_dot2_f32_bf16 v193, v56, v253, v193
  v_dot2_f32_bf16 v194, v57, v252, v194
  v_dot2_f32_bf16 v195, v57, v253, v195
  v_dot2_f32_bf16 v196, v58, v252, v196
  v_dot2_f32_bf16 v197, v58, v253, v197
  v_dot2_f32_bf16 v198, v59, v252, v198
  v_dot2_f32_bf16 v199, v59, v253, v199
  s_waitcnt vmcnt(0)
  v_dot2_f32_bf16 v200, v60, v252, v200
  v_dot2_f32_bf16 v201, v60, v253, v201
  v_dot2_f32_bf16 v202, v61, v252, v202
  v_dot2_f32_bf16 v203, v61, v253, v203
  v_dot2_f32_bf16 v204, v62, v252, v204
  v_dot2_f32_bf16 v205, v62, v253, v205
  v_dot2_f32_bf16 v206, v63, v252, v206
  v_dot2_f32_bf16 v207, v63, v253, v207
  v_cvt_pk_bf16_f32 v16, v192, v193
  v_cvt_pk_bf16_f32 v17, v194, v195
  v_cvt_pk_bf16_f32 v18, v196, v197
  v_cvt_pk_bf16_f32 v19, v198, v199
s_nop 0
  v_permlane32_swap_b32 v16, v18
  v_permlane32_swap_b32 v17, v19
  buffer_store_dwordx4 v[16:19], v250, s[56:59], s17 offen offset:0
  v_cvt_pk_bf16_f32 v20, v200, v201
  v_cvt_pk_bf16_f32 v21, v202, v203
  v_cvt_pk_bf16_f32 v22, v204, v205
  v_cvt_pk_bf16_f32 v23, v206, v207
s_nop 0
  v_permlane32_swap_b32 v20, v22
  v_permlane32_swap_b32 v21, v23
  buffer_store_dwordx4 v[20:23], v250, s[56:59], s17 offen offset:512
  s_or_b32 s3, s2, s4
  s_cmp_lg_u32 s3, 0
  s_cbranch_scc1 L_fin
  v_mov_b32 v248, s68
  buffer_store_dword v248, off, s[36:39], 0 sc1
L_fin:
  s_endpgm
slow_lc54:
  ds_read_b32 v3, v1 offset:48
  s_add_u32 s67, s67, 1
  s_waitcnt lgkmcnt(0)
  v_cmp_gt_u32 vcc, 2, v3
  s_cmp_ge_u32 s67, 131072
  s_cbranch_scc1 back_lc54
  s_cbranch_vccnz slow_lc54
  s_branch back_lc54
slow_lc56:
  ds_read_b32 v3, v1 offset:48
  s_add_u32 s67, s67, 1
  s_waitcnt lgkmcnt(0)
  v_cmp_gt_u32 vcc, 3, v3
  s_cmp_ge_u32 s67, 131072
  s_cbranch_scc1 back_lc56
  s_cbranch_vccnz slow_lc56
  s_branch back_lc56
slow_sc57:
  s_add_u32 s67, s67, 8
  s_cmp_ge_u32 s67, 131072
  s_cbranch_scc1 back_sc57
  s_xor_b32 s20, s10, 0
  s_buffer_load_dword s20, s[36:39], s20 glc
  s_xor_b32 s21, s10, 128
  s_buffer_load_dword s21, s[36:39], s21 glc
  s_xor_b32 s22, s10, 256
  s_buffer_load_dword s22, s[36:39], s22 glc
  s_xor_b32 s23, s10, 384
  s_buffer_load_dword s23, s[36:39], s23 glc
  s_waitcnt lgkmcnt(0)
  s_sub_u32 s20, s20, s68
  s_sub_u32 s21, s21, s68
  s_or_b32 s20, s20, s21
  s_sub_u32 s22, s22, s68
  s_or_b32 s20, s20, s22
  s_sub_u32 s23, s23, s68
  s_or_b32 s20, s20, s23
  s_cmp_ge_u32 s20, 1
  s_cbranch_scc1 slow_sc57
  s_branch back_sc57
slow_p:
  s_waitcnt lgkmcnt(0)
  s_xor_b64 s[40:41], s[20:21], s[68:69]
  s_xor_b64 s[42:43], s[22:23], s[68:69]
  s_or_b64 s[40:41], s[40:41], s[42:43]
  s_cbranch_scc0 back_p
  s_buffer_load_dwordx4 s[20:23], s[36:39], s16 offset:0 glc
  s_add_u32 s67, s67, 8
  s_cmp_lt_u32 s67, 131072
  s_cbranch_scc1 slow_p
  s_branch back_p
slow_lc59:
  ds_read_b32 v3, v1 offset:896
  s_add_u32 s67, s67, 1
  s_waitcnt lgkmcnt(0)
  v_cmp_ne_u32 vcc, 0, v3
  s_cmp_ge_u32 s67, 131072
  s_cbranch_scc1 back_lc59
  s_cbranch_vccnz slow_lc59
  s_branch back_lc59
slow_lc61:
  ds_read_b32 v3, v1 offset:912
  s_add_u32 s67, s67, 1
  s_waitcnt lgkmcnt(0)
  v_cmp_ne_u32 vcc, 0, v3
  s_cmp_ge_u32 s67, 131072
  s_cbranch_scc1 back_lc61
  s_cbranch_vccnz slow_lc61
  s_branch back_lc61
slow_lc63:
  ds_read_b32 v3, v1 offset:80
  s_add_u32 s67, s67, 1
  s_waitcnt lgkmcnt(0)
  v_cmp_gt_u32 vcc, 1, v3
  s_cmp_ge_u32 s67, 131072
  s_cbranch_scc1 back_lc63
  s_cbranch_vccnz slow_lc63
  s_branch back_lc63
slow_lc65:
  ds_read_b32 v3, v1 offset:112
  s_add_u32 s67, s67, 1
  s_waitcnt lgkmcnt(0)
  v_cmp_gt_u32 vcc, 1, v3
  s_cmp_ge_u32 s67, 131072
  s_cbranch_scc1 back_lc65
  s_cbranch_vccnz slow_lc65
  s_branch back_lc65
L_end:
  s_endpgm
.section .rodata,"a"
.p2align 6
.amdhsa_kernel gated_mix__spectral_gfnet__dense_activation_silu__prompt_kernel
  .amdhsa_next_free_vgpr 256
  .amdhsa_next_free_sgpr 102
  .amdhsa_accum_offset 256
  .amdhsa_group_segment_fixed_size 0
  .amdhsa_kernarg_size 80
  .amdhsa_user_sgpr_count 2
  .amdhsa_user_sgpr_kernarg_segment_ptr 1
  .amdhsa_system_sgpr_workgroup_id_x 1
.end_amdhsa_kernel
```
